```python
import torch

def _softmax(x, axis=-1):
    return torch.softmax(x, dim=axis)
def _gelu(x):
    return torch.nn.functional.gelu(x, approximate="tanh")
def _silu(x):
    return torch.nn.functional.silu(x)
def _sigmoid(x):
    return torch.sigmoid(x)
def _layernorm(x, axis=-1, eps=1e-5):
    m = x.mean(dim=axis, keepdim=True)
    v = x.var(dim=axis, keepdim=True, unbiased=False)
    return (x - m) / torch.sqrt(v + eps)
def _scatter_add(tgt, idx, src, axis=0):
    return tgt.clone().index_add_(axis, idx, src)
def _segment_sum(src, seg, n):
    out = torch.zeros((n,) + src.shape[1:], dtype=src.dtype)
    return out.index_add_(0, seg, src)
def _pad(x, pw):
    flat = tuple(v for pair in reversed(pw) for v in pair)
    return torch.nn.functional.pad(x, flat)

kernel_name = 'parallel_sum__linear_kernel_hedgehog__swiglu_ffn__prompt'

def setup_inputs():

    _w = (lambda a: (lambda t: t.to(torch.bfloat16) if t.is_floating_point() else t)(torch.as_tensor(a)))
    def _A_setup():
        B, S, D, H = 1, 2048, 640, 32
        Dh = D // H
        return {
            "x": _w((lambda *s: torch.randn(*s, dtype=torch.bfloat16) * 0.05)(B, S, D)),
            "wqkv": _w((lambda *s: torch.randn(*s, dtype=torch.bfloat16) * 0.4)(D, 3 * D)),
            "w_phi": _w((lambda *s: torch.randn(*s, dtype=torch.bfloat16) * 0.4)(H, Dh, Dh) * (Dh ** -0.5)),
            "wo": _w((lambda *s: torch.randn(*s, dtype=torch.bfloat16) * 0.1)(D, D)),
        }
    _A_in = _A_setup()

    def _B_setup():
        B, S, D, F = 1, 2048, 640, 1536
        return {
            "x": _w((lambda *s: torch.randn(*s, dtype=torch.bfloat16) * 0.05)(B, S, D)),
            "w_gate": _w((lambda *s: torch.randn(*s, dtype=torch.bfloat16) * 0.05)(D, F)),
            "w_up": _w((lambda *s: torch.randn(*s, dtype=torch.bfloat16) * 0.05)(D, F)),
            "w_down": _w((lambda *s: torch.randn(*s, dtype=torch.bfloat16) * 0.05)(F, D)),
        }
    _B_in = _B_setup()

    return {
        "A_x": _A_in["x"],
        "A_wqkv": _A_in["wqkv"],
        "A_w_phi": _A_in["w_phi"],
        "A_wo": _A_in["wo"],
        "B_x": _B_in["x"],
        "B_w_gate": _B_in["w_gate"],
        "B_w_up": _B_in["w_up"],
        "B_w_down": _B_in["w_down"],
    }

def reference(A_x, A_wqkv, A_w_phi, A_wo, B_x, B_w_gate, B_w_up, B_w_down):
    def _A_ref(x, wqkv, w_phi, wo):
        B, S, D = x.shape
        H = 32; Dh = D // H
        qkv = (lambda x, *d: x.permute(*d))((x @ wqkv).reshape(B, S, 3, H, Dh), 2, 0, 3, 1, 4)
        q, k, v = qkv[0], qkv[1], qkv[2]
        pq = torch.einsum("bhsd,hdf->bhsf", q, w_phi)
        pk = torch.einsum("bhsd,hdf->bhsf", k, w_phi)
        phi_q = torch.concatenate([_softmax(pq, axis=-1), _softmax(-pq, axis=-1)], axis=-1)
        phi_k = torch.concatenate([_softmax(pk, axis=-1), _softmax(-pk, axis=-1)], axis=-1)
        kv = torch.einsum("bhsf,bhsd->bhfd", phi_k, v)
        z  = torch.einsum("bhsf->bhf", phi_k)
        num = torch.einsum("bhqf,bhfd->bhqd", phi_q, kv)
        den = torch.einsum("bhqf,bhf->bhq", phi_q, z)[..., None] + 1e-6
        o = num / den
        return (lambda x, *d: x.permute(*d))(o, 0, 2, 1, 3).reshape(B, S, D) @ wo

    def _B_ref(x, w_gate, w_up, w_down):
        g = _silu(x @ w_gate)
        u = x @ w_up
        return (g * u) @ w_down

    x = A_x
    xn = _layernorm(x, axis=-1)
    return x + _A_ref(xn, A_wqkv, A_w_phi, A_wo) + _B_ref(xn, B_w_gate, B_w_up, B_w_down)
```

```asm
; @launch grid=(256,1,1) block=(512,1,1) lds=163840
.amdgcn_target "amdgcn-amd-amdhsa--gfx950"
.text
.globl parallel_sum__linear_kernel_hedgehog__swiglu_ffn__prompt_kernel
.p2align 8
.type parallel_sum__linear_kernel_hedgehog__swiglu_ffn__prompt_kernel,@function
parallel_sum__linear_kernel_hedgehog__swiglu_ffn__prompt_kernel:
    s_load_dwordx16 s[4:19], s[0:1], 0
    s_load_dwordx4 s[20:23], s[0:1], 64
    s_load_dwordx2 s[24:25], s[0:1], 80
    s_cmp_ge_u32 s2, 256
    s_cbranch_scc1 L_end
    v_lshrrev_b32 v2, 6, v0
    v_and_b32 v1, 63, v0
    v_readfirstlane_b32 s52, v2
    s_and_b32 s86, s2, 7
    s_lshr_b32 s78, s2, 3
    s_and_b32 s53, s86, 1
    s_lshl_b32 s53, s53, 2
    s_and_b32 s79, s78, 3
    s_add_u32 s53, s53, s79
    s_lshr_b32 s97, s78, 2
    s_lshr_b32 s96, s86, 1
    s_lshl_b32 s56, s96, 3
    s_add_u32 s56, s56, s97
    s_mul_i32 s79, s96, 5
    s_add_u32 s79, s79, s97
    s_sub_u32 s55, s79, 3
    s_mov_b32 s54, 2
    s_cmp_eq_u32 s97, 2
    s_cselect_b32 s54, 1, s54
    s_cselect_b32 s55, s96, s55
    s_lshl_b32 s79, s96, 1
    s_add_u32 s79, s79, s97
    s_cmp_lt_u32 s97, 2
    s_cselect_b32 s54, 0, s54
    s_cselect_b32 s55, s79, s55
    s_lshr_b32 s94, s52, 2
    s_mul_i32 s79, s55, 5
    s_lshl_b32 s80, s55, 2
    s_add_u32 s80, s80, 16
    s_cmp_lt_u32 s55, 16
    s_cselect_b32 s95, s79, s80
    s_lshl_b32 s61, s95, 5
    s_mul_i32 s79, s55, 160
    s_mul_i32 s80, s94, 1280
    s_add_u32 s79, s79, s80
    s_add_u32 s79, s79, 1280
    s_cmp_eq_u32 s54, 0
    s_cselect_b32 s61, s79, s61
    s_mul_i32 s79, s55, 320
    s_mul_i32 s80, s94, 160
    s_add_u32 s79, s79, s80
    s_cmp_eq_u32 s54, 1
    s_cselect_b32 s61, s79, s61
    s_movk_i32 s63, 3840
    s_cmp_eq_u32 s54, 2
    s_cselect_b32 s63, 3072, s63
    s_lshl_b32 s76, s63, 6
    v_lshlrev_b32 v8, 5, v1
    v_mov_b32 v7, 1073741824
    v_cmp_gt_u32 vcc, 40, v1
    s_nop 1
    v_cndmask_b32 v8, v7, v8, vcc
    v_lshrrev_b32 v5, 4, v1
    v_and_b32 v6, 15, v1
    v_mul_u32_u24 v5, s63, v5
    v_lshl_add_u32 v15, v6, 4, v5
    v_cmp_gt_u32 vcc, 10, v6
    s_nop 1
    v_cndmask_b32 v15, v7, v15, vcc
    s_lshl_b32 s78, s53, 8
    s_lshl_b32 s79, s56, 3
    s_add_u32 s78, s78, s79
    s_add_u32 s97, s78, s52
    s_mul_i32 s78, s97, 1280
    s_and_b32 s79, s52, 3
    s_mul_i32 s80, s79, 20
    s_mul_i32 s81, s53, 80
    s_add_u32 s80, s80, s81
    s_mul_i32 s80, s80, s63
    s_add_u32 s84, s80, s61
    s_lshl_b32 s85, s63, 2
    v_lshrrev_b32 v3, 3, v1
    v_and_b32 v4, 7, v1
    v_lshrrev_b32 v5, 4, v1
    v_mul_u32_u24 v6, 1280, v3
    v_xor_b32 v7, v5, v4
    v_lshl_add_u32 v16, v7, 4, v6
    v_add_u32 v5, 4, v5
    v_xor_b32 v7, v5, v4
    v_lshl_add_u32 v17, v7, 4, v6
    s_lshl_b32 s80, s53, 8
    s_lshl_b32 s81, s52, 5
    s_add_u32 s80, s80, s81
    s_mul_i32 s58, s80, 1280
    s_lshl_b32 s72, s52, 12
    s_cmp_lt_u32 s79, 2
    s_cselect_b32 s77, 1, 0
    s_lshl_b32 s80, s79, 6
    v_add_u32 v5, s80, v1
    v_mul_u32_u24 v6, 6554, v5
    v_lshrrev_b32 v6, 16, v6
    v_mul_u32_u24 v7, 10, v6
    v_sub_u32 v7, v5, v7
    v_mul_u32_u24 v6, s63, v6
    v_lshl_add_u32 v18, v7, 4, v6
    v_add_u32 v5, s80, v1
    v_add_u32 v5, 256, v5
    v_mul_u32_u24 v6, 6554, v5
    v_lshrrev_b32 v6, 16, v6
    v_mul_u32_u24 v7, 10, v6
    v_sub_u32 v7, v5, v7
    v_mul_u32_u24 v6, s63, v6
    v_lshl_add_u32 v19, v7, 4, v6
    v_add_u32 v5, s80, v1
    v_add_u32 v5, 512, v5
    v_mul_u32_u24 v6, 6554, v5
    v_lshrrev_b32 v6, 16, v6
    v_mul_u32_u24 v7, 10, v6
    v_sub_u32 v7, v5, v7
    v_mul_u32_u24 v6, s63, v6
    v_lshl_add_u32 v20, v7, 4, v6
    s_mul_i32 s71, s94, 10368
    s_lshl_b32 s80, s79, 10
    s_add_u32 s71, s71, s80
    s_add_u32 s71, s71, 98304
    s_mov_b32 s82, 1073741824
    s_mov_b32 s62, s71
    s_mov_b32 s59, s72
    v_and_b32 v5, 31, v1
    v_lshrrev_b32 v6, 5, v1
    v_lshrrev_b32 v7, 1, v5
    v_and_b32 v7, 7, v7
    v_xor_b32 v7, v7, v6
    v_lshlrev_b32 v7, 4, v7
    v_lshl_add_u32 v5, v5, 7, v7
    v_add_u32 v5, s72, v5
    v_xor_b32 v10, 0, v5
    v_xor_b32 v11, 32, v5
    v_xor_b32 v12, 64, v5
    v_xor_b32 v13, 96, v5
    v_lshrrev_b32 v5, 4, v1
    v_and_b32 v6, 1, v5
    v_mul_u32_u24 v6, 10368, v6
    v_lshrrev_b32 v5, 1, v5
    v_lshlrev_b32 v5, 3, v5
    v_bfe_u32 v7, v1, 2, 2
    v_add_u32 v5, v5, v7
    v_mul_u32_u24 v5, 160, v5
    v_and_b32 v7, 3, v1
    v_lshl_add_u32 v5, v7, 3, v5
    v_add_u32 v5, v5, v6
    v_add_u32 v14, 98304, v5
    v_and_b32 v5, 1, v1
    v_lshlrev_b32 v5, 4, v5
    v_mov_b32 v6, 0x3f80
    v_lshlrev_b32 v5, v5, v6
    v_bfe_u32 v6, v1, 1, 3
    v_cmp_eq_u32 vcc, 0, v6
    s_nop 1
    v_cndmask_b32 v88, 0, v5, vcc
    v_cmp_eq_u32 vcc, 1, v6
    s_nop 1
    v_cndmask_b32 v89, 0, v5, vcc
    v_cmp_eq_u32 vcc, 2, v6
    s_nop 1
    v_cndmask_b32 v90, 0, v5, vcc
    v_cmp_eq_u32 vcc, 3, v6
    s_nop 1
    v_cndmask_b32 v91, 0, v5, vcc
    v_mov_b32 v92, 0x3f803f80
    v_mov_b32 v60, 0
    v_mov_b32 v61, 0
    v_mov_b32 v62, 0
    v_mov_b32 v63, 0
    v_mov_b32 v93, 1073741824
    v_cmp_eq_u32 vcc, 0, v1
    s_nop 1
    v_cndmask_b32 v93, v93, v1, vcc
    s_mov_b32 s68, 0xffff0000
    s_mov_b32 s64, 20608
    s_mov_b32 s65, 4294926080
    s_mov_b32 s66, 32768
    s_mov_b32 s67, 4294901760
    s_add_u32 s69, s71, 61824
    s_add_u32 s70, s72, 98304
    s_mov_b32 s73, 0
    s_mov_b32 s57, 0
    s_mov_b32 s96, 0
    s_mov_b32 s83, 991
    s_mov_b32 s93, s78
    s_waitcnt lgkmcnt(0)
    s_mov_b32 s28, s4
    s_mov_b32 s29, s5
    s_mov_b32 s30, 2621440
    s_mov_b32 s31, 0x00020000
    s_cmp_eq_u32 s94, 0
    s_cselect_b32 s32, s14, s16
    s_cselect_b32 s33, s15, s17
    s_cmp_eq_u32 s54, 2
    s_cselect_b32 s32, s32, s6
    s_cselect_b32 s33, s33, s7
    s_mov_b32 s79, 2457600
    s_cselect_b32 s34, 1966080, s79
    s_mov_b32 s35, 0x00020000
    s_add_u32 m0, s62, 0
    s_nop 0
    buffer_load_dwordx4 v18, s[32:35], s61 offen lds
    s_add_u32 m0, s62, 4096
    s_nop 0
    buffer_load_dwordx4 v19, s[32:35], s61 offen lds
    s_add_u32 s80, s62, 8192
    s_cmp_lg_u32 s77, 0
    s_cselect_b32 m0, s80, 162816
    s_cselect_b32 s79, s61, s82
    buffer_load_dwordx4 v20, s[32:35], s79 offen lds
    s_add_u32 m0, s59, 0
    s_add_u32 s81, s58, 0
    buffer_load_dwordx4 v16, s[28:31], s81 offen lds
    s_add_u32 m0, s59, 1024
    s_add_u32 s81, s58, 10240
    buffer_load_dwordx4 v17, s[28:31], s81 offen lds
    s_add_u32 m0, s59, 2048
    s_add_u32 s81, s58, 20480
    buffer_load_dwordx4 v16, s[28:31], s81 offen lds
    s_add_u32 m0, s59, 3072
    s_add_u32 s81, s58, 30720
    buffer_load_dwordx4 v17, s[28:31], s81 offen lds
    buffer_load_dwordx4 v[156:159], v8, s[28:31], s93 offen
    buffer_load_dwordx4 v[160:163], v8, s[28:31], s93 offen offset:16
    s_add_u32 s61, s61, s76
    s_add_u32 s58, s58, 128
    s_add_u32 s62, s62, 20608
    s_add_u32 s59, s59, 32768
    s_add_u32 m0, s62, 0
    s_nop 0
    buffer_load_dwordx4 v18, s[32:35], s61 offen lds
    s_add_u32 m0, s62, 4096
    s_nop 0
    buffer_load_dwordx4 v19, s[32:35], s61 offen lds
    s_add_u32 s80, s62, 8192
    s_cmp_lg_u32 s77, 0
    s_cselect_b32 m0, s80, 162816
    s_cselect_b32 s79, s61, s82
    buffer_load_dwordx4 v20, s[32:35], s79 offen lds
    s_add_u32 m0, s59, 0
    s_add_u32 s81, s58, 0
    buffer_load_dwordx4 v16, s[28:31], s81 offen lds
    s_add_u32 m0, s59, 1024
    s_add_u32 s81, s58, 10240
    buffer_load_dwordx4 v17, s[28:31], s81 offen lds
    s_add_u32 m0, s59, 2048
    s_add_u32 s81, s58, 20480
    buffer_load_dwordx4 v16, s[28:31], s81 offen lds
    s_add_u32 m0, s59, 3072
    s_add_u32 s81, s58, 30720
    buffer_load_dwordx4 v17, s[28:31], s81 offen lds
    s_add_u32 s61, s61, s76
    s_add_u32 s58, s58, 128
    s_add_u32 s62, s62, 20608
    s_add_u32 s59, s59, 32768
    s_mov_b32 s36, s24
    s_mov_b32 s37, s25
    s_mov_b32 s38, 9230336
    s_mov_b32 s39, 0x00020000
    s_mov_b32 s40, s22
    s_mov_b32 s41, s23
    s_mov_b32 s42, 256
    s_mov_b32 s43, 0x00020000
    s_mov_b32 s12, s18
    s_mov_b32 s13, s19
    s_mov_b32 s14, 1966080
    s_mov_b32 s15, 0x00020000
    s_mov_b32 s44, s8
    s_mov_b32 s45, s9
    s_mov_b32 s46, 25600
    s_mov_b32 s47, 0x00020000
    s_cmp_eq_u32 s54, 0
    s_cbranch_scc0 L_nozkv
    s_cmp_eq_u32 s53, 0
    s_cbranch_scc0 L_nozkv
    s_lshl_b32 s78, s55, 14
    s_lshl_b32 s79, s52, 11
    s_add_u32 s78, s78, s79
    s_add_u32 s78, s78, 8912896
    v_lshlrev_b32 v7, 4, v1
    buffer_store_dwordx4 v[60:63], v7, s[36:39], s78 offen sc1
    buffer_store_dwordx4 v[60:63], v7, s[36:39], s78 offen offset:1024 sc1
    s_lshl_b32 s78, s55, 8
    s_add_u32 s78, s78, 9064448
    buffer_store_dword v60, v93, s[36:39], s78 offen sc1
    s_branch L_zdone
L_nozkv:
    s_cmp_eq_u32 s56, 3
    s_cbranch_scc0 L_zdone
    s_lshl_b32 s78, s53, 8
    s_add_u32 s78, s78, 9060352
    buffer_store_dword v60, v93, s[36:39], s78 offen sc1
    s_add_u32 s78, s78, 2048
    buffer_store_dword v60, v93, s[36:39], s78 offen sc1
L_zdone:
    s_cmp_eq_u32 s52, 0
    s_cbranch_scc0 L_nozl
    v_mov_b32 v7, 160128
    ds_write_b128 v7, v[60:63]
    v_mov_b32 v4, 0x3f80
    v_mov_b32 v5, 0
    ds_write_b64 v7, v[4:5] offset:16
L_nozl:
    v_mov_b32 v34, 0
    v_mov_b32 v35, 0
    v_mov_b32 v38, 0
    v_mov_b32 v39, 0
    v_mov_b32 v42, 0
    v_mov_b32 v43, 0
    v_mov_b32 v46, 0
    v_mov_b32 v47, 0
    v_mov_b32 v50, 0
    v_mov_b32 v51, 0
    s_mov_b32 s94, s93
    s_lshr_b32 s78, s2, 3
    s_sub_u32 s79, s78, 12
    s_cmp_eq_u32 s54, 2
    s_cselect_b32 s93, 1, 0
    s_cselect_b32 s79, s79, 0
    s_mul_i32 s80, s86, 20
    s_add_u32 s80, s80, s79
    s_mul_i32 s88, s80, 6554
    s_lshr_b32 s88, s88, 16
    s_mul_i32 s78, s88, 10
    s_sub_u32 s89, s80, s78
    v_lshrrev_b32 v2, 3, v1
    v_and_b32 v3, 7, v1
    v_bfe_u32 v4, v2, 1, 1
    v_lshlrev_b32 v4, 2, v4
    v_xor_b32 v3, v3, v4
    v_lshlrev_b32 v3, 4, v3
    v_lshrrev_b32 v4, 2, v2
    v_lshlrev_b32 v4, 3, v4
    v_and_b32 v5, 3, v2
    v_add_u32 v4, v4, v5
    v_mul_u32_u24 v4, 1280, v4
    v_add_u32 v100, v4, v3
    v_add_u32 v101, 5120, v100
    v_mul_u32_u24 v4, 2560, v2
    v_add_u32 v102, v4, v3
    v_add_u32 v103, 1280, v102
    s_and_b32 s78, s52, 1
    s_cmp_eq_u32 s78, 0
    s_cselect_b64 vcc, -1, 0
    v_cndmask_b32 v99, v101, v100, vcc
    s_waitcnt vmcnt(9)
    s_waitcnt lgkmcnt(0)
    s_barrier
    ds_read_b128 v[128:131], v10
    ds_read_b64_tr_b16 v[136:137], v14 offset:0
    ds_read_b64_tr_b16 v[138:139], v14 offset:640
    ds_read_b64_tr_b16 v[140:141], v14 offset:32
    ds_read_b64_tr_b16 v[142:143], v14 offset:672
    ds_read_b64_tr_b16 v[144:145], v14 offset:64
    ds_read_b64_tr_b16 v[146:147], v14 offset:704
    ds_read_b64_tr_b16 v[148:149], v14 offset:96
    ds_read_b64_tr_b16 v[150:151], v14 offset:736
    ds_read_b64_tr_b16 v[152:153], v14 offset:128
    ds_read_b64_tr_b16 v[154:155], v14 offset:768
    s_waitcnt lgkmcnt(8)
    v_mfma_f32_32x32x16_bf16 v[176:191], v[136:139], v[128:131], 0
    ds_read_b128 v[132:135], v11
    ds_read_b64_tr_b16 v[136:137], v14 offset:2560
    ds_read_b64_tr_b16 v[138:139], v14 offset:3200
    s_add_u32 m0, s71, 41216
    s_nop 0
    buffer_load_dwordx4 v18, s[32:35], s61 offen lds
    s_waitcnt lgkmcnt(9)
    v_mfma_f32_32x32x16_bf16 v[192:207], v[140:143], v[128:131], 0
    ds_read_b64_tr_b16 v[140:141], v14 offset:2592
    ds_read_b64_tr_b16 v[142:143], v14 offset:3232
    s_waitcnt lgkmcnt(9)
    v_mfma_f32_32x32x16_bf16 v[208:223], v[144:147], v[128:131], 0
    ds_read_b64_tr_b16 v[144:145], v14 offset:2624
    ds_read_b64_tr_b16 v[146:147], v14 offset:3264
    s_add_u32 m0, s72, 65536
    s_add_u32 s73, s58, 0
    buffer_load_dwordx4 v16, s[28:31], s73 offen lds
    s_waitcnt lgkmcnt(9)
    v_mfma_f32_32x32x16_bf16 v[224:239], v[148:151], v[128:131], 0
    ds_read_b64_tr_b16 v[148:149], v14 offset:2656
    ds_read_b64_tr_b16 v[150:151], v14 offset:3296
    s_waitcnt lgkmcnt(9)
    v_mfma_f32_32x32x16_bf16 v[240:255], v[152:155], v[128:131], 0
    ds_read_b64_tr_b16 v[152:153], v14 offset:2688
    ds_read_b64_tr_b16 v[154:155], v14 offset:3328
    s_add_u32 m0, s71, 45312
    s_nop 0
    buffer_load_dwordx4 v19, s[32:35], s61 offen lds
    s_waitcnt lgkmcnt(8)
    v_mfma_f32_32x32x16_bf16 v[176:191], v[136:139], v[132:135], v[176:191]
    ds_read_b128 v[128:131], v12
    ds_read_b64_tr_b16 v[136:137], v14 offset:5120
    ds_read_b64_tr_b16 v[138:139], v14 offset:5760
    buffer_load_dwordx4 v[64:67], v15, s[32:35], s84 offen
    s_add_u32 s84, s84, s85
    s_waitcnt lgkmcnt(9)
    v_mfma_f32_32x32x16_bf16 v[192:207], v[140:143], v[132:135], v[192:207]
    ds_read_b64_tr_b16 v[140:141], v14 offset:5152
    ds_read_b64_tr_b16 v[142:143], v14 offset:5792
    s_add_u32 m0, s72, 66560
    s_add_u32 s73, s58, 10240
    buffer_load_dwordx4 v17, s[28:31], s73 offen lds
    buffer_load_dwordx4 v[68:71], v15, s[32:35], s84 offen
    s_add_u32 s84, s84, s85
    s_waitcnt lgkmcnt(9)
    v_mfma_f32_32x32x16_bf16 v[208:223], v[144:147], v[132:135], v[208:223]
    ds_read_b64_tr_b16 v[144:145], v14 offset:5184
    ds_read_b64_tr_b16 v[146:147], v14 offset:5824
    buffer_load_dwordx4 v[72:75], v15, s[32:35], s84 offen
    s_add_u32 s84, s84, s85
    s_waitcnt lgkmcnt(9)
    v_mfma_f32_32x32x16_bf16 v[224:239], v[148:151], v[132:135], v[224:239]
    ds_read_b64_tr_b16 v[148:149], v14 offset:5216
    ds_read_b64_tr_b16 v[150:151], v14 offset:5856
    s_add_u32 s74, s71, 49408
    s_cmp_lg_u32 s77, 0
    s_cselect_b32 m0, s74, 162816
    s_cselect_b32 s75, s61, s82
    buffer_load_dwordx4 v20, s[32:35], s75 offen lds
    s_add_u32 s61, s61, s76
    buffer_load_dwordx4 v[76:79], v15, s[32:35], s84 offen
    s_add_u32 s84, s84, s85
    s_waitcnt lgkmcnt(9)
    v_mfma_f32_32x32x16_bf16 v[240:255], v[152:155], v[132:135], v[240:255]
    ds_read_b64_tr_b16 v[152:153], v14 offset:5248
    ds_read_b64_tr_b16 v[154:155], v14 offset:5888
    buffer_load_dwordx4 v[80:83], v15, s[32:35], s84 offen
    s_waitcnt lgkmcnt(8)
    v_mfma_f32_32x32x16_bf16 v[176:191], v[136:139], v[128:131], v[176:191]
    ds_read_b128 v[132:135], v13
    ds_read_b64_tr_b16 v[136:137], v14 offset:7680
    ds_read_b64_tr_b16 v[138:139], v14 offset:8320
    s_add_u32 m0, s72, 67584
    s_add_u32 s73, s58, 20480
    buffer_load_dwordx4 v16, s[28:31], s73 offen lds
    s_waitcnt vmcnt(18)
    v_mov_b32 v2, 0
    v_mov_b32 v4, 0
    v_lshlrev_b32 v6, 16, v156
    s_waitcnt lgkmcnt(9)
    v_mfma_f32_32x32x16_bf16 v[192:207], v[140:143], v[128:131], v[192:207]
    ds_read_b64_tr_b16 v[140:141], v14 offset:7712
    ds_read_b64_tr_b16 v[142:143], v14 offset:8352
    v_and_b32 v7, s68, v156
    v_add_f32 v2, v2, v6
    v_fmac_f32 v4, v6, v6
    s_waitcnt lgkmcnt(9)
    v_mfma_f32_32x32x16_bf16 v[208:223], v[144:147], v[128:131], v[208:223]
    ds_read_b64_tr_b16 v[144:145], v14 offset:7744
    ds_read_b64_tr_b16 v[146:147], v14 offset:8384
    s_add_u32 m0, s72, 68608
    s_add_u32 s73, s58, 30720
    buffer_load_dwordx4 v17, s[28:31], s73 offen lds
    v_add_f32 v2, v2, v7
    v_fmac_f32 v4, v7, v7
    v_lshlrev_b32 v6, 16, v157
    s_waitcnt lgkmcnt(9)
    v_mfma_f32_32x32x16_bf16 v[224:239], v[148:151], v[128:131], v[224:239]
    ds_read_b64_tr_b16 v[148:149], v14 offset:7776
    ds_read_b64_tr_b16 v[150:151], v14 offset:8416
    v_and_b32 v7, s68, v157
    v_add_f32 v2, v2, v6
    v_fmac_f32 v4, v6, v6
    s_waitcnt lgkmcnt(9)
    v_mfma_f32_32x32x16_bf16 v[240:255], v[152:155], v[128:131], v[240:255]
    ds_read_b64_tr_b16 v[152:153], v14 offset:7808
    ds_read_b64_tr_b16 v[154:155], v14 offset:8448
    v_add_f32 v2, v2, v7
    v_fmac_f32 v4, v7, v7
    v_lshlrev_b32 v6, 16, v158
    s_waitcnt vmcnt(12) lgkmcnt(0)
    s_barrier
    v_add_u32 v10, 0x8000, v10
    s_waitcnt lgkmcnt(8)
    v_mfma_f32_32x32x16_bf16 v[176:191], v[136:139], v[132:135], v[176:191]
    ds_read_b128 v[128:131], v10
    ds_read_b64_tr_b16 v[136:137], v14 offset:20608
    ds_read_b64_tr_b16 v[138:139], v14 offset:21248
    s_add_u32 m0, s71, 0
    s_nop 0
    buffer_load_dwordx4 v18, s[32:35], s61 offen lds
    v_add_u32 v11, 0x8000, v11
    v_add_u32 v12, 0x8000, v12
    v_add_u32 v13, 0x8000, v13
    s_waitcnt lgkmcnt(9)
    v_mfma_f32_32x32x16_bf16 v[192:207], v[140:143], v[132:135], v[192:207]
    ds_read_b64_tr_b16 v[140:141], v14 offset:20640
    ds_read_b64_tr_b16 v[142:143], v14 offset:21280
    s_add_u32 m0, s72, 0
    s_add_u32 s73, s58, 128
    buffer_load_dwordx4 v16, s[28:31], s73 offen lds
    v_and_b32 v7, s68, v158
    v_add_f32 v2, v2, v6
    v_fmac_f32 v4, v6, v6
    s_waitcnt lgkmcnt(9)
    v_mfma_f32_32x32x16_bf16 v[208:223], v[144:147], v[132:135], v[208:223]
    ds_read_b64_tr_b16 v[144:145], v14 offset:20672
    ds_read_b64_tr_b16 v[146:147], v14 offset:21312
    s_add_u32 m0, s71, 4096
    s_nop 0
    buffer_load_dwordx4 v19, s[32:35], s61 offen lds
    v_add_f32 v2, v2, v7
    v_fmac_f32 v4, v7, v7
    v_lshlrev_b32 v6, 16, v159
    s_waitcnt lgkmcnt(9)
    v_mfma_f32_32x32x16_bf16 v[224:239], v[148:151], v[132:135], v[224:239]
    ds_read_b64_tr_b16 v[148:149], v14 offset:20704
    ds_read_b64_tr_b16 v[150:151], v14 offset:21344
    v_and_b32 v7, s68, v159
    v_add_f32 v2, v2, v6
    v_fmac_f32 v4, v6, v6
    s_waitcnt lgkmcnt(9)
    v_mfma_f32_32x32x16_bf16 v[240:255], v[152:155], v[132:135], v[240:255]
    ds_read_b64_tr_b16 v[152:153], v14 offset:20736
    ds_read_b64_tr_b16 v[154:155], v14 offset:21376
    s_add_u32 m0, s72, 1024
    s_add_u32 s73, s58, 10368
    buffer_load_dwordx4 v17, s[28:31], s73 offen lds
    v_add_f32 v2, v2, v7
    v_fmac_f32 v4, v7, v7
    v_lshlrev_b32 v6, 16, v160
    s_waitcnt lgkmcnt(8)
    v_mfma_f32_32x32x16_bf16 v[176:191], v[136:139], v[128:131], v[176:191]
    ds_read_b128 v[132:135], v11
    ds_read_b64_tr_b16 v[136:137], v14 offset:23168
    ds_read_b64_tr_b16 v[138:139], v14 offset:23808
    s_add_u32 s74, s71, 8192
    s_cmp_lg_u32 s77, 0
    s_cselect_b32 m0, s74, 162816
    s_cselect_b32 s75, s61, s82
    buffer_load_dwordx4 v20, s[32:35], s75 offen lds
    s_add_u32 s61, s61, s76
    v_and_b32 v7, s68, v160
    v_add_f32 v2, v2, v6
    v_fmac_f32 v4, v6, v6
    s_waitcnt lgkmcnt(9)
    v_mfma_f32_32x32x16_bf16 v[192:207], v[140:143], v[128:131], v[192:207]
    ds_read_b64_tr_b16 v[140:141], v14 offset:23200
    ds_read_b64_tr_b16 v[142:143], v14 offset:23840
    v_add_f32 v2, v2, v7
    v_fmac_f32 v4, v7, v7
    v_lshlrev_b32 v6, 16, v161
    s_waitcnt lgkmcnt(9)
    v_mfma_f32_32x32x16_bf16 v[208:223], v[144:147], v[128:131], v[208:223]
    ds_read_b64_tr_b16 v[144:145], v14 offset:23232
    ds_read_b64_tr_b16 v[146:147], v14 offset:23872
    s_add_u32 m0, s72, 2048
    s_add_u32 s73, s58, 20608
    buffer_load_dwordx4 v16, s[28:31], s73 offen lds
    v_and_b32 v7, s68, v161
    v_add_f32 v2, v2, v6
    v_fmac_f32 v4, v6, v6
    s_waitcnt lgkmcnt(9)
    v_mfma_f32_32x32x16_bf16 v[224:239], v[148:151], v[128:131], v[224:239]
    ds_read_b64_tr_b16 v[148:149], v14 offset:23264
    ds_read_b64_tr_b16 v[150:151], v14 offset:23904
    v_add_f32 v2, v2, v7
    v_fmac_f32 v4, v7, v7
    v_lshlrev_b32 v6, 16, v162
    s_waitcnt lgkmcnt(9)
    v_mfma_f32_32x32x16_bf16 v[240:255], v[152:155], v[128:131], v[240:255]
    ds_read_b64_tr_b16 v[152:153], v14 offset:23296
    ds_read_b64_tr_b16 v[154:155], v14 offset:23936
    s_add_u32 m0, s72, 3072
    s_add_u32 s73, s58, 30848
    buffer_load_dwordx4 v17, s[28:31], s73 offen lds
    v_and_b32 v7, s68, v162
    v_add_f32 v2, v2, v6
    v_fmac_f32 v4, v6, v6
    s_waitcnt lgkmcnt(8)
    v_mfma_f32_32x32x16_bf16 v[176:191], v[136:139], v[132:135], v[176:191]
    ds_read_b128 v[128:131], v12
    ds_read_b64_tr_b16 v[136:137], v14 offset:25728
    ds_read_b64_tr_b16 v[138:139], v14 offset:26368
    v_add_f32 v2, v2, v7
    v_fmac_f32 v4, v7, v7
    v_lshlrev_b32 v6, 16, v163
    s_waitcnt lgkmcnt(9)
    v_mfma_f32_32x32x16_bf16 v[192:207], v[140:143], v[132:135], v[192:207]
    ds_read_b64_tr_b16 v[140:141], v14 offset:25760
    ds_read_b64_tr_b16 v[142:143], v14 offset:26400
    v_and_b32 v7, s68, v163
    v_add_f32 v2, v2, v6
    v_fmac_f32 v4, v6, v6
    s_waitcnt lgkmcnt(9)
    v_mfma_f32_32x32x16_bf16 v[208:223], v[144:147], v[132:135], v[208:223]
    ds_read_b64_tr_b16 v[144:145], v14 offset:25792
    ds_read_b64_tr_b16 v[146:147], v14 offset:26432
    v_add_f32 v2, v2, v7
    v_fmac_f32 v4, v7, v7
    s_nop 0
    v_add_f32_dpp v2, v2, v2 row_ror:8 row_mask:0xf bank_mask:0xf
    s_waitcnt lgkmcnt(9)
    v_mfma_f32_32x32x16_bf16 v[224:239], v[148:151], v[132:135], v[224:239]
    ds_read_b64_tr_b16 v[148:149], v14 offset:25824
    ds_read_b64_tr_b16 v[150:151], v14 offset:26464
    v_add_f32_dpp v4, v4, v4 row_ror:8 row_mask:0xf bank_mask:0xf
    v_add_f32_dpp v2, v2, v2 row_ror:4 row_mask:0xf bank_mask:0xf
    s_nop 0
    v_add_f32_dpp v4, v4, v4 row_ror:4 row_mask:0xf bank_mask:0xf
    s_waitcnt lgkmcnt(9)
    v_mfma_f32_32x32x16_bf16 v[240:255], v[152:155], v[132:135], v[240:255]
    ds_read_b64_tr_b16 v[152:153], v14 offset:25856
    ds_read_b64_tr_b16 v[154:155], v14 offset:26496
    v_add_f32_dpp v2, v2, v2 row_ror:2 row_mask:0xf bank_mask:0xf
    v_add_f32_dpp v4, v4, v4 row_ror:2 row_mask:0xf bank_mask:0xf
    s_nop 0
    v_add_f32_dpp v2, v2, v2 row_ror:1 row_mask:0xf bank_mask:0xf
    s_waitcnt lgkmcnt(8)
    v_mfma_f32_32x32x16_bf16 v[176:191], v[136:139], v[128:131], v[176:191]
    ds_read_b128 v[132:135], v13
    ds_read_b64_tr_b16 v[136:137], v14 offset:28288
    ds_read_b64_tr_b16 v[138:139], v14 offset:28928
    v_add_f32_dpp v4, v4, v4 row_ror:1 row_mask:0xf bank_mask:0xf
    v_mov_b32 v3, v2
    v_mov_b32 v5, v4
    s_waitcnt lgkmcnt(9)
    v_mfma_f32_32x32x16_bf16 v[192:207], v[140:143], v[128:131], v[192:207]
    ds_read_b64_tr_b16 v[140:141], v14 offset:28320
    ds_read_b64_tr_b16 v[142:143], v14 offset:28960
    v_permlane16_swap_b32 v2, v3
    v_permlane16_swap_b32 v4, v5
    v_add_f32 v2, v2, v3
    s_waitcnt lgkmcnt(9)
    v_mfma_f32_32x32x16_bf16 v[208:223], v[144:147], v[128:131], v[208:223]
    ds_read_b64_tr_b16 v[144:145], v14 offset:28352
    ds_read_b64_tr_b16 v[146:147], v14 offset:28992
    v_add_f32 v4, v4, v5
    v_mov_b32 v3, v2
    v_mov_b32 v5, v4
    s_waitcnt lgkmcnt(9)
    v_mfma_f32_32x32x16_bf16 v[224:239], v[148:151], v[128:131], v[224:239]
    ds_read_b64_tr_b16 v[148:149], v14 offset:28384
    ds_read_b64_tr_b16 v[150:151], v14 offset:29024
    v_permlane32_swap_b32 v2, v3
    v_permlane32_swap_b32 v4, v5
    v_add_f32 v2, v2, v3
    s_waitcnt lgkmcnt(9)
    v_mfma_f32_32x32x16_bf16 v[240:255], v[152:155], v[128:131], v[240:255]
    ds_read_b64_tr_b16 v[152:153], v14 offset:28416
    ds_read_b64_tr_b16 v[154:155], v14 offset:29056
    v_add_f32 v5, v4, v5
    v_mul_f32 v4, 0x3acccccd, v2
    v_mul_f32 v5, 0x3acccccd, v5
    v_fma_f32 v5, -v4, v4, v5
    v_max_f32 v5, 0, v5
    v_add_f32 v5, 0x3727c5ac, v5
    s_lshl_b32 s78, s97, 3
    s_add_u32 s78, s78, 9043968
    buffer_store_dwordx2 v[4:5], v93, s[36:39], s78 offen sc1
    s_lshr_b32 s78, s52, 1
    s_and_b32 s79, s52, 1
    s_lshl_b32 s80, s55, 2
    s_lshl_b32 s81, s55, 3
    s_cmp_eq_u32 s54, 0
    s_cselect_b32 s80, s80, s81
    s_add_u32 s80, s80, s78
    s_mul_i32 s80, s80, 800
    s_and_b32 s81, s78, 1
    s_lshl_b32 s79, s79, 2
    s_sub_u32 s79, s79, s81
    v_bfe_u32 v2, v1, 3, 2
    v_and_b32 v3, 3, v1
    v_lshl_add_u32 v2, v2, 2, v3
    v_bfe_u32 v3, v1, 2, 1
    v_mul_u32_u24 v3, 10, v3
    v_add_u32 v3, v3, v2
    v_lshrrev_b32 v4, 5, v1
    v_add_u32 v4, s79, v4
    v_mul_u32_u24 v5, 160, v4
    v_lshl_add_u32 v5, v3, 1, v5
    v_cmp_gt_u32 vcc, 5, v4
    v_mov_b32 v6, 1073741824
    s_nop 0
    v_cndmask_b32 v5, v6, v5, vcc
    v_cmp_gt_u32 vcc, 10, v2
    s_nop 1
    v_cndmask_b32 v5, v6, v5, vcc
    s_cmp_eq_u32 s54, 2
    s_cbranch_scc1 L_phisk_1
    buffer_load_ushort v104, v5, s[44:47], s80 offen offset:0
    buffer_load_ushort v105, v5, s[44:47], s80 offen offset:40
    buffer_load_ushort v106, v5, s[44:47], s80 offen offset:80
    buffer_load_ushort v107, v5, s[44:47], s80 offen offset:120
L_phisk_1:
    v_add_u32 v4, 2, v4
    v_mul_u32_u24 v5, 160, v4
    v_lshl_add_u32 v5, v3, 1, v5
    v_cmp_gt_u32 vcc, 5, v4
    v_mov_b32 v6, 1073741824
    s_nop 0
    v_cndmask_b32 v5, v6, v5, vcc
    v_cmp_gt_u32 vcc, 10, v2
    s_nop 1
    v_cndmask_b32 v5, v6, v5, vcc
    s_cmp_eq_u32 s54, 2
    s_cbranch_scc1 L_phisk_2
    buffer_load_ushort v108, v5, s[44:47], s80 offen offset:0
    buffer_load_ushort v109, v5, s[44:47], s80 offen offset:40
    buffer_load_ushort v110, v5, s[44:47], s80 offen offset:80
    buffer_load_ushort v111, v5, s[44:47], s80 offen offset:120
L_phisk_2:
    s_lshr_b32 s78, s52, 1
    s_and_b32 s79, s52, 1
    s_lshl_b32 s80, s55, 2
    s_lshl_b32 s81, s55, 3
    s_cmp_eq_u32 s54, 0
    s_cselect_b32 s80, s80, s81
    s_add_u32 s80, s80, s78
    s_add_u32 s80, s80, 4
    s_mul_i32 s80, s80, 800
    s_and_b32 s81, s78, 1
    s_lshl_b32 s79, s79, 2
    s_sub_u32 s79, s79, s81
    v_bfe_u32 v2, v1, 3, 2
    v_and_b32 v3, 3, v1
    v_lshl_add_u32 v2, v2, 2, v3
    v_bfe_u32 v3, v1, 2, 1
    v_mul_u32_u24 v3, 10, v3
    v_add_u32 v3, v3, v2
    v_lshrrev_b32 v4, 5, v1
    v_add_u32 v4, s79, v4
    v_mul_u32_u24 v5, 160, v4
    v_lshl_add_u32 v5, v3, 1, v5
    v_cmp_gt_u32 vcc, 5, v4
    v_mov_b32 v6, 1073741824
    s_nop 0
    v_cndmask_b32 v5, v6, v5, vcc
    v_cmp_gt_u32 vcc, 10, v2
    s_nop 1
    v_cndmask_b32 v5, v6, v5, vcc
    s_cmp_lg_u32 s54, 1
    s_cbranch_scc1 L_phisk_3
    buffer_load_ushort v112, v5, s[44:47], s80 offen offset:0
    buffer_load_ushort v113, v5, s[44:47], s80 offen offset:40
    buffer_load_ushort v114, v5, s[44:47], s80 offen offset:80
    buffer_load_ushort v115, v5, s[44:47], s80 offen offset:120
L_phisk_3:
    v_add_u32 v4, 2, v4
    v_mul_u32_u24 v5, 160, v4
    v_lshl_add_u32 v5, v3, 1, v5
    v_cmp_gt_u32 vcc, 5, v4
    v_mov_b32 v6, 1073741824
    s_nop 0
    v_cndmask_b32 v5, v6, v5, vcc
    v_cmp_gt_u32 vcc, 10, v2
    s_nop 1
    v_cndmask_b32 v5, v6, v5, vcc
    s_cmp_lg_u32 s54, 1
    s_cbranch_scc1 L_phisk_4
    buffer_load_ushort v116, v5, s[44:47], s80 offen offset:0
    buffer_load_ushort v117, v5, s[44:47], s80 offen offset:40
    buffer_load_ushort v118, v5, s[44:47], s80 offen offset:80
    buffer_load_ushort v119, v5, s[44:47], s80 offen offset:120
L_phisk_4:
    s_waitcnt vmcnt(8) lgkmcnt(0)
    s_barrier
    v_add_u32 v10, 0x8000, v10
    s_waitcnt lgkmcnt(8)
    v_mfma_f32_32x32x16_bf16 v[176:191], v[136:139], v[132:135], v[176:191]
    ds_read_b128 v[128:131], v10
    ds_read_b64_tr_b16 v[136:137], v14 offset:41216
    ds_read_b64_tr_b16 v[138:139], v14 offset:41856
    s_add_u32 m0, s71, 20608
    s_nop 0
    buffer_load_dwordx4 v18, s[32:35], s61 offen lds
    v_add_u32 v11, 0x8000, v11
    v_add_u32 v12, 0x8000, v12
    v_add_u32 v13, 0x8000, v13
    s_waitcnt lgkmcnt(9)
    v_mfma_f32_32x32x16_bf16 v[192:207], v[140:143], v[132:135], v[192:207]
    ds_read_b64_tr_b16 v[140:141], v14 offset:41248
    ds_read_b64_tr_b16 v[142:143], v14 offset:41888
    s_add_u32 m0, s72, 32768
    s_add_u32 s73, s58, 256
    buffer_load_dwordx4 v16, s[28:31], s73 offen lds
    v_mfma_f32_16x16x32_bf16 v[84:87], v[88:91], v[64:67], 0
    v_mfma_f32_16x16x32_bf16 v[84:87], v[88:91], v[68:71], v[84:87]
    v_mfma_f32_16x16x32_bf16 v[84:87], v[88:91], v[72:75], v[84:87]
    s_waitcnt lgkmcnt(9)
    v_mfma_f32_32x32x16_bf16 v[208:223], v[144:147], v[132:135], v[208:223]
    ds_read_b64_tr_b16 v[144:145], v14 offset:41280
    ds_read_b64_tr_b16 v[146:147], v14 offset:41920
    s_add_u32 m0, s71, 24704
    s_nop 0
    buffer_load_dwordx4 v19, s[32:35], s61 offen lds
    v_mfma_f32_16x16x32_bf16 v[84:87], v[88:91], v[76:79], v[84:87]
    v_mfma_f32_16x16x32_bf16 v[84:87], v[88:91], v[80:83], v[84:87]
    v_and_b32 v6, 15, v1
    s_waitcnt lgkmcnt(9)
    v_mfma_f32_32x32x16_bf16 v[224:239], v[148:151], v[132:135], v[224:239]
    ds_read_b64_tr_b16 v[148:149], v14 offset:41312
    ds_read_b64_tr_b16 v[150:151], v14 offset:41952
    v_lshrrev_b32 v7, 4, v1
    v_lshlrev_b32 v5, 5, v6
    v_lshl_add_u32 v5, v7, 4, v5
    s_waitcnt lgkmcnt(9)
    v_mfma_f32_32x32x16_bf16 v[240:255], v[152:155], v[132:135], v[240:255]
    ds_read_b64_tr_b16 v[152:153], v14 offset:41344
    ds_read_b64_tr_b16 v[154:155], v14 offset:41984
    s_add_u32 m0, s72, 33792
    s_add_u32 s73, s58, 10496
    buffer_load_dwordx4 v17, s[28:31], s73 offen lds
    s_mul_i32 s78, s52, 320
    s_add_u32 s78, s78, 160256
    v_add_u32 v5, s78, v5
    s_waitcnt lgkmcnt(8)
    v_mfma_f32_32x32x16_bf16 v[176:191], v[136:139], v[128:131], v[176:191]
    ds_read_b128 v[132:135], v11
    ds_read_b64_tr_b16 v[136:137], v14 offset:43776
    ds_read_b64_tr_b16 v[138:139], v14 offset:44416
    s_add_u32 s74, s71, 28800
    s_cmp_lg_u32 s77, 0
    s_cselect_b32 m0, s74, 162816
    s_cselect_b32 s75, s61, s82
    buffer_load_dwordx4 v20, s[32:35], s75 offen lds
    s_add_u32 s61, s61, s76
    v_mov_b32 v3, 162816
    v_cmp_gt_u32 vcc, 10, v6
    s_nop 1
    v_cndmask_b32 v5, v3, v5, vcc
    s_waitcnt lgkmcnt(9)
    v_mfma_f32_32x32x16_bf16 v[192:207], v[140:143], v[128:131], v[192:207]
    ds_read_b64_tr_b16 v[140:141], v14 offset:43808
    ds_read_b64_tr_b16 v[142:143], v14 offset:44448
    v_cmp_gt_u32 vcc, 2, v7
    s_nop 1
    v_cndmask_b32 v5, v3, v5, vcc
    s_waitcnt lgkmcnt(9)
    v_mfma_f32_32x32x16_bf16 v[208:223], v[144:147], v[128:131], v[208:223]
    ds_read_b64_tr_b16 v[144:145], v14 offset:43840
    ds_read_b64_tr_b16 v[146:147], v14 offset:44480
    s_add_u32 m0, s72, 34816
    s_add_u32 s73, s58, 20736
    buffer_load_dwordx4 v16, s[28:31], s73 offen lds
    s_nop 4
    ds_write_b128 v5, v[84:87]
    s_waitcnt lgkmcnt(9)
    v_mfma_f32_32x32x16_bf16 v[224:239], v[148:151], v[128:131], v[224:239]
    ds_read_b64_tr_b16 v[148:149], v14 offset:43872
    ds_read_b64_tr_b16 v[150:151], v14 offset:44512
    s_waitcnt lgkmcnt(9)
    v_mfma_f32_32x32x16_bf16 v[240:255], v[152:155], v[128:131], v[240:255]
    ds_read_b64_tr_b16 v[152:153], v14 offset:43904
    ds_read_b64_tr_b16 v[154:155], v14 offset:44544
    s_add_u32 m0, s72, 35840
    s_add_u32 s73, s58, 30976
    buffer_load_dwordx4 v17, s[28:31], s73 offen lds
    s_waitcnt lgkmcnt(8)
    v_mfma_f32_32x32x16_bf16 v[176:191], v[136:139], v[132:135], v[176:191]
    ds_read_b128 v[128:131], v12
    ds_read_b64_tr_b16 v[136:137], v14 offset:46336
    ds_read_b64_tr_b16 v[138:139], v14 offset:46976
    s_waitcnt lgkmcnt(9)
    v_mfma_f32_32x32x16_bf16 v[192:207], v[140:143], v[132:135], v[192:207]
    ds_read_b64_tr_b16 v[140:141], v14 offset:46368
    ds_read_b64_tr_b16 v[142:143], v14 offset:47008
    s_waitcnt lgkmcnt(9)
    v_mfma_f32_32x32x16_bf16 v[208:223], v[144:147], v[132:135], v[208:223]
    ds_read_b64_tr_b16 v[144:145], v14 offset:46400
    ds_read_b64_tr_b16 v[146:147], v14 offset:47040
    s_waitcnt lgkmcnt(9)
    v_mfma_f32_32x32x16_bf16 v[224:239], v[148:151], v[132:135], v[224:239]
    ds_read_b64_tr_b16 v[148:149], v14 offset:46432
    ds_read_b64_tr_b16 v[150:151], v14 offset:47072
    s_waitcnt lgkmcnt(9)
    v_mfma_f32_32x32x16_bf16 v[240:255], v[152:155], v[132:135], v[240:255]
    ds_read_b64_tr_b16 v[152:153], v14 offset:46464
    ds_read_b64_tr_b16 v[154:155], v14 offset:47104
    s_waitcnt lgkmcnt(8)
    v_mfma_f32_32x32x16_bf16 v[176:191], v[136:139], v[128:131], v[176:191]
    ds_read_b128 v[132:135], v13
    ds_read_b64_tr_b16 v[136:137], v14 offset:48896
    ds_read_b64_tr_b16 v[138:139], v14 offset:49536
    s_waitcnt lgkmcnt(9)
    v_mfma_f32_32x32x16_bf16 v[192:207], v[140:143], v[128:131], v[192:207]
    ds_read_b64_tr_b16 v[140:141], v14 offset:48928
    ds_read_b64_tr_b16 v[142:143], v14 offset:49568
    s_waitcnt lgkmcnt(9)
    v_mfma_f32_32x32x16_bf16 v[208:223], v[144:147], v[128:131], v[208:223]
    ds_read_b64_tr_b16 v[144:145], v14 offset:48960
    ds_read_b64_tr_b16 v[146:147], v14 offset:49600
    s_waitcnt lgkmcnt(9)
    v_mfma_f32_32x32x16_bf16 v[224:239], v[148:151], v[128:131], v[224:239]
    ds_read_b64_tr_b16 v[148:149], v14 offset:48992
    ds_read_b64_tr_b16 v[150:151], v14 offset:49632
    s_waitcnt lgkmcnt(9)
    v_mfma_f32_32x32x16_bf16 v[240:255], v[152:155], v[128:131], v[240:255]
    ds_read_b64_tr_b16 v[152:153], v14 offset:49024
    ds_read_b64_tr_b16 v[154:155], v14 offset:49664
    s_waitcnt vmcnt(8) lgkmcnt(0)
    s_barrier
    v_add_u32 v10, 0xffff0000, v10
    s_waitcnt lgkmcnt(8)
    v_mfma_f32_32x32x16_bf16 v[176:191], v[136:139], v[132:135], v[176:191]
    ds_read_b128 v[128:131], v10
    ds_read_b64_tr_b16 v[136:137], v14 offset:0
    ds_read_b64_tr_b16 v[138:139], v14 offset:640
    s_add_u32 m0, s71, 41216
    s_nop 0
    buffer_load_dwordx4 v18, s[32:35], s61 offen lds
    v_add_u32 v11, 0xffff0000, v11
    v_add_u32 v12, 0xffff0000, v12
    v_add_u32 v13, 0xffff0000, v13
    s_waitcnt lgkmcnt(9)
    v_mfma_f32_32x32x16_bf16 v[192:207], v[140:143], v[132:135], v[192:207]
    ds_read_b64_tr_b16 v[140:141], v14 offset:32
    ds_read_b64_tr_b16 v[142:143], v14 offset:672
    s_add_u32 m0, s72, 65536
    s_add_u32 s73, s58, 384
    buffer_load_dwordx4 v16, s[28:31], s73 offen lds
    s_cmp_eq_u32 s52, 0
    s_cbranch_scc0 L_w0_5
    v_cmp_le_u32 vcc, 10, v1
    v_subrev_u32 v7, 10, v1
    s_nop 0
    v_cndmask_b32 v7, v1, v7, vcc
    v_cndmask_b32 v8, 0, 1, vcc
    v_mul_u32_u24 v5, 1280, v8
    v_lshl_add_u32 v5, v7, 5, v5
    v_add_u32 v5, 160256, v5
    v_mov_b32 v6, 160128
    v_cmp_gt_u32 vcc, 20, v1
    s_nop 1
    v_cndmask_b32 v5, v6, v5, vcc
    ds_read_b128 v[64:67], v5 offset:0
    ds_read_b128 v[68:71], v5 offset:16
    ds_read_b128 v[72:75], v5 offset:320
    ds_read_b128 v[76:79], v5 offset:336
    ds_read_b128 v[80:83], v5 offset:640
    ds_read_b128 v[84:87], v5 offset:656
    ds_read_b128 v[88:91], v5 offset:960
    ds_read_b128 v[92:95], v5 offset:976
    v_lshrrev_b32 v5, 1, v7
    v_lshlrev_b32 v5, 5, v5
    v_lshl_add_u32 v5, v8, 4, v5
    v_and_b32 v6, 1, v7
    v_lshl_add_u32 v5, v6, 3, v5
    v_lshlrev_b32 v5, 2, v5
    v_mov_b32 v6, 1073741824
    v_cndmask_b32 v5, v6, v5, vcc
    s_lshl_b32 s78, s56, 3
    s_add_u32 s78, s78, s53
    s_mul_i32 s78, s78, 640
    s_add_u32 s78, s78, 9066496
    s_waitcnt lgkmcnt(0)
    v_add_f32 v64, v64, v72
    v_add_f32 v80, v80, v88
    v_add_f32 v64, v64, v80
    v_add_f32 v65, v65, v73
    v_add_f32 v81, v81, v89
    v_add_f32 v65, v65, v81
    v_add_f32 v66, v66, v74
    v_add_f32 v82, v82, v90
    v_add_f32 v66, v66, v82
    v_add_f32 v67, v67, v75
    v_add_f32 v83, v83, v91
    v_add_f32 v67, v67, v83
    v_add_f32 v68, v68, v76
    v_add_f32 v84, v84, v92
    v_add_f32 v68, v68, v84
    v_add_f32 v69, v69, v77
    v_add_f32 v85, v85, v93
    v_add_f32 v69, v69, v85
    v_add_f32 v70, v70, v78
    v_add_f32 v86, v86, v94
    v_add_f32 v70, v70, v86
    v_add_f32 v71, v71, v79
    v_add_f32 v87, v87, v95
    v_add_f32 v71, v71, v87
    buffer_store_dwordx4 v[64:67], v5, s[36:39], s78 offen sc1
    buffer_store_dwordx4 v[68:71], v5, s[36:39], s78 offen offset:16 sc1
L_w0_5:
    s_waitcnt lgkmcnt(9)
    v_mfma_f32_32x32x16_bf16 v[208:223], v[144:147], v[132:135], v[208:223]
    ds_read_b64_tr_b16 v[144:145], v14 offset:64
    ds_read_b64_tr_b16 v[146:147], v14 offset:704
    s_add_u32 m0, s71, 45312
    s_nop 0
    buffer_load_dwordx4 v19, s[32:35], s61 offen lds
    s_waitcnt lgkmcnt(9)
    v_mfma_f32_32x32x16_bf16 v[224:239], v[148:151], v[132:135], v[224:239]
    ds_read_b64_tr_b16 v[148:149], v14 offset:96
    ds_read_b64_tr_b16 v[150:151], v14 offset:736
    s_waitcnt lgkmcnt(9)
    v_mfma_f32_32x32x16_bf16 v[240:255], v[152:155], v[132:135], v[240:255]
    ds_read_b64_tr_b16 v[152:153], v14 offset:128
    ds_read_b64_tr_b16 v[154:155], v14 offset:768
    s_add_u32 m0, s72, 66560
    s_add_u32 s73, s58, 10624
    buffer_load_dwordx4 v17, s[28:31], s73 offen lds
    s_waitcnt lgkmcnt(8)
    v_mfma_f32_32x32x16_bf16 v[176:191], v[136:139], v[128:131], v[176:191]
    ds_read_b128 v[132:135], v11
    ds_read_b64_tr_b16 v[136:137], v14 offset:2560
    ds_read_b64_tr_b16 v[138:139], v14 offset:3200
    s_add_u32 s74, s71, 49408
    s_cmp_lg_u32 s77, 0
    s_cselect_b32 m0, s74, 162816
    s_cselect_b32 s75, s61, s82
    buffer_load_dwordx4 v20, s[32:35], s75 offen lds
    s_add_u32 s61, s61, s76
    s_waitcnt lgkmcnt(9)
    v_mfma_f32_32x32x16_bf16 v[192:207], v[140:143], v[128:131], v[192:207]
    ds_read_b64_tr_b16 v[140:141], v14 offset:2592
    ds_read_b64_tr_b16 v[142:143], v14 offset:3232
    s_waitcnt lgkmcnt(9)
    v_mfma_f32_32x32x16_bf16 v[208:223], v[144:147], v[128:131], v[208:223]
    ds_read_b64_tr_b16 v[144:145], v14 offset:2624
    ds_read_b64_tr_b16 v[146:147], v14 offset:3264
    s_add_u32 m0, s72, 67584
    s_add_u32 s73, s58, 20864
    buffer_load_dwordx4 v16, s[28:31], s73 offen lds
    s_waitcnt lgkmcnt(9)
    v_mfma_f32_32x32x16_bf16 v[224:239], v[148:151], v[128:131], v[224:239]
    ds_read_b64_tr_b16 v[148:149], v14 offset:2656
    ds_read_b64_tr_b16 v[150:151], v14 offset:3296
    s_waitcnt lgkmcnt(9)
    v_mfma_f32_32x32x16_bf16 v[240:255], v[152:155], v[128:131], v[240:255]
    ds_read_b64_tr_b16 v[152:153], v14 offset:2688
    ds_read_b64_tr_b16 v[154:155], v14 offset:3328
    s_add_u32 m0, s72, 68608
    s_add_u32 s73, s58, 31104
    buffer_load_dwordx4 v17, s[28:31], s73 offen lds
    s_waitcnt lgkmcnt(8)
    v_mfma_f32_32x32x16_bf16 v[176:191], v[136:139], v[132:135], v[176:191]
    ds_read_b128 v[128:131], v12
    ds_read_b64_tr_b16 v[136:137], v14 offset:5120
    ds_read_b64_tr_b16 v[138:139], v14 offset:5760
    s_waitcnt lgkmcnt(9)
    v_mfma_f32_32x32x16_bf16 v[192:207], v[140:143], v[132:135], v[192:207]
    ds_read_b64_tr_b16 v[140:141], v14 offset:5152
    ds_read_b64_tr_b16 v[142:143], v14 offset:5792
    s_waitcnt lgkmcnt(9)
    v_mfma_f32_32x32x16_bf16 v[208:223], v[144:147], v[132:135], v[208:223]
    ds_read_b64_tr_b16 v[144:145], v14 offset:5184
    ds_read_b64_tr_b16 v[146:147], v14 offset:5824
    s_waitcnt lgkmcnt(9)
    v_mfma_f32_32x32x16_bf16 v[224:239], v[148:151], v[132:135], v[224:239]
    ds_read_b64_tr_b16 v[148:149], v14 offset:5216
    ds_read_b64_tr_b16 v[150:151], v14 offset:5856
    s_waitcnt lgkmcnt(9)
    v_mfma_f32_32x32x16_bf16 v[240:255], v[152:155], v[132:135], v[240:255]
    ds_read_b64_tr_b16 v[152:153], v14 offset:5248
    ds_read_b64_tr_b16 v[154:155], v14 offset:5888
    s_waitcnt lgkmcnt(8)
    v_mfma_f32_32x32x16_bf16 v[176:191], v[136:139], v[128:131], v[176:191]
    ds_read_b128 v[132:135], v13
    ds_read_b64_tr_b16 v[136:137], v14 offset:7680
    ds_read_b64_tr_b16 v[138:139], v14 offset:8320
    s_waitcnt lgkmcnt(9)
    v_mfma_f32_32x32x16_bf16 v[192:207], v[140:143], v[128:131], v[192:207]
    ds_read_b64_tr_b16 v[140:141], v14 offset:7712
    ds_read_b64_tr_b16 v[142:143], v14 offset:8352
    s_waitcnt lgkmcnt(9)
    v_mfma_f32_32x32x16_bf16 v[208:223], v[144:147], v[128:131], v[208:223]
    ds_read_b64_tr_b16 v[144:145], v14 offset:7744
    ds_read_b64_tr_b16 v[146:147], v14 offset:8384
    s_waitcnt lgkmcnt(9)
    v_mfma_f32_32x32x16_bf16 v[224:239], v[148:151], v[128:131], v[224:239]
    ds_read_b64_tr_b16 v[148:149], v14 offset:7776
    ds_read_b64_tr_b16 v[150:151], v14 offset:8416
    s_waitcnt lgkmcnt(9)
    v_mfma_f32_32x32x16_bf16 v[240:255], v[152:155], v[128:131], v[240:255]
    ds_read_b64_tr_b16 v[152:153], v14 offset:7808
    ds_read_b64_tr_b16 v[154:155], v14 offset:8448
    s_waitcnt vmcnt(7) lgkmcnt(0)
    s_barrier
    v_add_u32 v10, 0x8000, v10
    s_waitcnt lgkmcnt(8)
    v_mfma_f32_32x32x16_bf16 v[176:191], v[136:139], v[132:135], v[176:191]
    ds_read_b128 v[128:131], v10
    ds_read_b64_tr_b16 v[136:137], v14 offset:20608
    ds_read_b64_tr_b16 v[138:139], v14 offset:21248
    s_add_u32 m0, s71, 0
    s_nop 0
    buffer_load_dwordx4 v18, s[32:35], s61 offen lds
    v_add_u32 v11, 0x8000, v11
    v_add_u32 v12, 0x8000, v12
    v_add_u32 v13, 0x8000, v13
    s_waitcnt lgkmcnt(9)
    v_mfma_f32_32x32x16_bf16 v[192:207], v[140:143], v[132:135], v[192:207]
    ds_read_b64_tr_b16 v[140:141], v14 offset:20640
    ds_read_b64_tr_b16 v[142:143], v14 offset:21280
    s_add_u32 m0, s72, 0
    s_add_u32 s73, s58, 512
    buffer_load_dwordx4 v16, s[28:31], s73 offen lds
    v_lshlrev_b32 v174, 4, v1
    v_add_u32 v172, 122880, v174
    v_and_b32 v5, 31, v1
    s_waitcnt lgkmcnt(9)
    v_mfma_f32_32x32x16_bf16 v[208:223], v[144:147], v[132:135], v[208:223]
    ds_read_b64_tr_b16 v[144:145], v14 offset:20672
    ds_read_b64_tr_b16 v[146:147], v14 offset:21312
    s_add_u32 m0, s71, 4096
    s_nop 0
    buffer_load_dwordx4 v19, s[32:35], s61 offen lds
    s_lshl_b32 s78, s52, 5
    v_add_u32 v5, s78, v5
    v_lshrrev_b32 v6, 5, v1
    s_waitcnt lgkmcnt(9)
    v_mfma_f32_32x32x16_bf16 v[224:239], v[148:151], v[132:135], v[224:239]
    ds_read_b64_tr_b16 v[148:149], v14 offset:20704
    ds_read_b64_tr_b16 v[150:151], v14 offset:21344
    v_mul_u32_u24 v170, 320, v5
    v_mul_u32_u24 v7, 40, v6
    v_add_u32 v170, v170, v7
    s_waitcnt lgkmcnt(9)
    v_mfma_f32_32x32x16_bf16 v[240:255], v[152:155], v[132:135], v[240:255]
    ds_read_b64_tr_b16 v[152:153], v14 offset:20736
    ds_read_b64_tr_b16 v[154:155], v14 offset:21376
    s_add_u32 m0, s72, 1024
    s_add_u32 s73, s58, 10752
    buffer_load_dwordx4 v17, s[28:31], s73 offen lds
    v_mul_u32_u24 v171, 160, v5
    v_lshl_add_u32 v171, v6, 3, v171
    v_add_u32 v171, 81920, v171
    s_waitcnt lgkmcnt(8)
    v_mfma_f32_32x32x16_bf16 v[176:191], v[136:139], v[128:131], v[176:191]
    ds_read_b128 v[132:135], v11
    ds_read_b64_tr_b16 v[136:137], v14 offset:23168
    ds_read_b64_tr_b16 v[138:139], v14 offset:23808
    s_add_u32 s74, s71, 8192
    s_cmp_lg_u32 s77, 0
    s_cselect_b32 m0, s74, 162816
    s_cselect_b32 s75, s61, s82
    buffer_load_dwordx4 v20, s[32:35], s75 offen lds
    s_add_u32 s61, s61, s76
    s_lshr_b32 s64, s52, 1
    s_and_b32 s65, s52, 1
    v_lshrrev_b32 v5, 4, v1
    s_waitcnt lgkmcnt(9)
    v_mfma_f32_32x32x16_bf16 v[192:207], v[140:143], v[128:131], v[192:207]
    ds_read_b64_tr_b16 v[140:141], v14 offset:23200
    ds_read_b64_tr_b16 v[142:143], v14 offset:23840
    v_and_b32 v6, 1, v5
    v_lshrrev_b32 v5, 1, v5
    v_bfe_u32 v7, v1, 2, 2
    s_waitcnt lgkmcnt(9)
    v_mfma_f32_32x32x16_bf16 v[208:223], v[144:147], v[128:131], v[208:223]
    ds_read_b64_tr_b16 v[144:145], v14 offset:23232
    ds_read_b64_tr_b16 v[146:147], v14 offset:23872
    s_add_u32 m0, s72, 2048
    s_add_u32 s73, s58, 20992
    buffer_load_dwordx4 v16, s[28:31], s73 offen lds
    v_lshl_add_u32 v5, v5, 3, v7
    v_and_b32 v7, 3, v1
    s_mul_i32 s80, s64, 40
    s_waitcnt lgkmcnt(9)
    v_mfma_f32_32x32x16_bf16 v[224:239], v[148:151], v[128:131], v[224:239]
    ds_read_b64_tr_b16 v[148:149], v14 offset:23264
    ds_read_b64_tr_b16 v[150:151], v14 offset:23904
    v_lshlrev_b32 v8, 3, v7
    v_add_u32 v8, s80, v8
    s_add_u32 s81, s80, 32
    s_waitcnt lgkmcnt(9)
    v_mfma_f32_32x32x16_bf16 v[240:255], v[152:155], v[128:131], v[240:255]
    ds_read_b64_tr_b16 v[152:153], v14 offset:23296
    ds_read_b64_tr_b16 v[154:155], v14 offset:23936
    s_add_u32 m0, s72, 3072
    s_add_u32 s73, s58, 31232
    buffer_load_dwordx4 v17, s[28:31], s73 offen lds
    v_mov_b32 v9, s81
    v_cmp_eq_u32 vcc, 0, v6
    s_nop 1
    v_cndmask_b32 v8, v9, v8, vcc
    s_waitcnt lgkmcnt(8)
    v_mfma_f32_32x32x16_bf16 v[176:191], v[136:139], v[132:135], v[176:191]
    ds_read_b128 v[128:131], v12
    ds_read_b64_tr_b16 v[136:137], v14 offset:25728
    ds_read_b64_tr_b16 v[138:139], v14 offset:26368
    v_mul_u32_u24 v9, 160, v5
    v_add_u32 v8, v8, v9
    v_add_u32 v164, 81920, v8
    s_waitcnt lgkmcnt(9)
    v_mfma_f32_32x32x16_bf16 v[192:207], v[140:143], v[132:135], v[192:207]
    ds_read_b64_tr_b16 v[140:141], v14 offset:25760
    ds_read_b64_tr_b16 v[142:143], v14 offset:26400
    v_cmp_ne_u32 vcc, 0, v7
    s_nop 1
    v_cndmask_b32 v2, 0, v6, vcc
    v_cmp_eq_u32 vcc, 0, v2
    v_mov_b32 v3, 160144
    s_waitcnt lgkmcnt(9)
    v_mfma_f32_32x32x16_bf16 v[208:223], v[144:147], v[132:135], v[208:223]
    ds_read_b64_tr_b16 v[144:145], v14 offset:25792
    ds_read_b64_tr_b16 v[146:147], v14 offset:26432
    v_cndmask_b32 v164, v3, v164, vcc
    v_mov_b32 v3, 640
    v_cndmask_b32 v165, 0, v3, vcc
    s_waitcnt lgkmcnt(9)
    v_mfma_f32_32x32x16_bf16 v[224:239], v[148:151], v[132:135], v[224:239]
    ds_read_b64_tr_b16 v[148:149], v14 offset:25824
    ds_read_b64_tr_b16 v[150:151], v14 offset:26464
    s_lshl_b32 s81, s65, 3
    v_lshl_add_u32 v8, v6, 2, v7
    v_add_u32 v8, s81, v8
    s_waitcnt lgkmcnt(9)
    v_mfma_f32_32x32x16_bf16 v[240:255], v[152:155], v[132:135], v[240:255]
    ds_read_b64_tr_b16 v[152:153], v14 offset:25856
    ds_read_b64_tr_b16 v[154:155], v14 offset:26496
    v_min_u32 v8, 9, v8
    v_lshlrev_b32 v8, 3, v8
    s_mul_i32 s80, s64, 80
    s_waitcnt lgkmcnt(8)
    v_mfma_f32_32x32x16_bf16 v[176:191], v[136:139], v[128:131], v[176:191]
    ds_read_b128 v[132:135], v13
    ds_read_b64_tr_b16 v[136:137], v14 offset:28288
    ds_read_b64_tr_b16 v[138:139], v14 offset:28928
    v_add_u32 v8, s80, v8
    v_mul_u32_u24 v9, 320, v5
    v_add_u32 v166, v8, v9
    s_waitcnt lgkmcnt(9)
    v_mfma_f32_32x32x16_bf16 v[192:207], v[140:143], v[128:131], v[192:207]
    ds_read_b64_tr_b16 v[140:141], v14 offset:28320
    ds_read_b64_tr_b16 v[142:143], v14 offset:28960
    v_add_u32 v167, 40960, v166
    v_and_b32 v5, 31, v1
    s_lshl_b32 s81, s65, 5
    s_waitcnt lgkmcnt(9)
    v_mfma_f32_32x32x16_bf16 v[208:223], v[144:147], v[128:131], v[208:223]
    ds_read_b64_tr_b16 v[144:145], v14 offset:28352
    ds_read_b64_tr_b16 v[146:147], v14 offset:28992
    v_add_u32 v5, s81, v5
    v_lshrrev_b32 v6, 5, v1
    v_mul_u32_u24 v7, 160, v6
    s_waitcnt lgkmcnt(9)
    v_mfma_f32_32x32x16_bf16 v[224:239], v[148:151], v[128:131], v[224:239]
    ds_read_b64_tr_b16 v[148:149], v14 offset:28384
    ds_read_b64_tr_b16 v[150:151], v14 offset:29024
    v_add_u32 v7, v7, v5
    v_lshlrev_b32 v7, 2, v7
    v_mov_b32 v8, 1073741824
    s_waitcnt lgkmcnt(9)
    v_mfma_f32_32x32x16_bf16 v[240:255], v[152:155], v[128:131], v[240:255]
    ds_read_b64_tr_b16 v[152:153], v14 offset:28416
    ds_read_b64_tr_b16 v[154:155], v14 offset:29056
    v_cmp_gt_u32 vcc, 40, v5
    s_nop 1
    v_cndmask_b32 v168, v8, v7, vcc
    v_cmp_eq_u32 vcc, 0, v6
    s_nop 1
    v_cndmask_b32 v169, v8, v168, vcc
    s_lshl_b32 s80, s55, 2
    s_add_u32 s80, s80, s64
    s_lshl_b32 s80, s80, 12
    s_add_u32 s66, s80, 8912896
    v_bfe_u32 v2, v1, 3, 2
    v_and_b32 v3, 3, v1
    v_lshl_add_u32 v2, v2, 2, v3
    v_bfe_u32 v3, v1, 2, 1
    v_lshl_add_u32 v3, v2, 1, v3
    v_mov_b32 v4, 20
    v_cmp_eq_u32 vcc, 10, v2
    s_nop 1
    v_cndmask_b32 v3, v3, v4, vcc
    v_mul_u32_u24 v3, 160, v3
    v_lshrrev_b32 v4, 5, v1
    v_mul_u32_u24 v4, 80, v4
    v_add_u32 v3, v3, v4
    v_mov_b32 v4, 1073741824
    v_cmp_gt_u32 vcc, 11, v2
    s_nop 1
    v_cndmask_b32 v173, v4, v3, vcc
    s_lshl_b32 s78, s2, 3
    s_add_u32 s78, s78, s52
    v_lshlrev_b32 v2, 7, v1
    v_mov_b32 v3, 1073741824
    v_cmp_gt_u32 vcc, 8, v1
    s_nop 1
    v_cndmask_b32 v4, v3, v2, vcc
    s_mul_i32 s60, s78, 960
    buffer_load_dword v123, v4, s[12:15], s60 offen
    v_cmp_gt_u32 vcc, 4, v1
    s_nop 1
    v_cndmask_b32 v4, v3, v2, vcc
    s_mul_i32 s60, s78, 400
    s_mov_b32 s12, s10
    s_mov_b32 s13, s11
    s_mov_b32 s14, 819200
    buffer_load_dword v123, v4, s[12:15], s60 offen
    s_waitcnt vmcnt(9) lgkmcnt(0)
    s_barrier
    v_add_u32 v10, 0x8000, v10
    s_waitcnt lgkmcnt(8)
    v_mfma_f32_32x32x16_bf16 v[176:191], v[136:139], v[132:135], v[176:191]
    ds_read_b128 v[128:131], v10
    ds_read_b64_tr_b16 v[136:137], v14 offset:41216
    ds_read_b64_tr_b16 v[138:139], v14 offset:41856
    s_add_u32 m0, s71, 20608
    s_nop 0
    buffer_load_dwordx4 v18, s[32:35], s61 offen lds
    v_add_u32 v11, 0x8000, v11
    v_add_u32 v12, 0x8000, v12
    v_add_u32 v13, 0x8000, v13
    s_waitcnt lgkmcnt(9)
    v_mfma_f32_32x32x16_bf16 v[192:207], v[140:143], v[132:135], v[192:207]
    ds_read_b64_tr_b16 v[140:141], v14 offset:41248
    ds_read_b64_tr_b16 v[142:143], v14 offset:41888
    s_add_u32 m0, s72, 32768
    s_add_u32 s73, s58, 640
    buffer_load_dwordx4 v16, s[28:31], s73 offen lds
    s_cmp_eq_u32 s52, 0
    s_cbranch_scc0 L_w0_6
    v_mov_b32 v2, 1
    v_mov_b32 v3, 1073741824
    v_cmp_eq_u32 vcc, 0, v1
    s_nop 1
    v_cndmask_b32 v3, v3, v1, vcc
    s_lshr_b32 s78, s53, 1
    s_lshl_b32 s78, s78, 6
    s_and_b32 s79, s53, 1
    s_lshl_b32 s79, s79, 2
    s_add_u32 s78, s78, s79
    buffer_atomic_add v2, v3, s[40:43], s78 offen
L_w0_6:
    s_waitcnt lgkmcnt(9)
    v_mfma_f32_32x32x16_bf16 v[208:223], v[144:147], v[132:135], v[208:223]
    ds_read_b64_tr_b16 v[144:145], v14 offset:41280
    ds_read_b64_tr_b16 v[146:147], v14 offset:41920
    s_add_u32 m0, s71, 24704
    s_nop 0
    buffer_load_dwordx4 v19, s[32:35], s61 offen lds
    s_waitcnt lgkmcnt(9)
    v_mfma_f32_32x32x16_bf16 v[224:239], v[148:151], v[132:135], v[224:239]
    ds_read_b64_tr_b16 v[148:149], v14 offset:41312
    ds_read_b64_tr_b16 v[150:151], v14 offset:41952
    s_waitcnt lgkmcnt(9)
    v_mfma_f32_32x32x16_bf16 v[240:255], v[152:155], v[132:135], v[240:255]
    ds_read_b64_tr_b16 v[152:153], v14 offset:41344
    ds_read_b64_tr_b16 v[154:155], v14 offset:41984
    s_add_u32 m0, s72, 33792
    s_add_u32 s73, s58, 10880
    buffer_load_dwordx4 v17, s[28:31], s73 offen lds
    s_waitcnt lgkmcnt(8)
    v_mfma_f32_32x32x16_bf16 v[176:191], v[136:139], v[128:131], v[176:191]
    ds_read_b128 v[132:135], v11
    ds_read_b64_tr_b16 v[136:137], v14 offset:43776
    ds_read_b64_tr_b16 v[138:139], v14 offset:44416
    s_add_u32 s74, s71, 28800
    s_cmp_lg_u32 s77, 0
    s_cselect_b32 m0, s74, 162816
    s_cselect_b32 s75, s61, s82
    buffer_load_dwordx4 v20, s[32:35], s75 offen lds
    s_add_u32 s61, s61, s76
    s_waitcnt lgkmcnt(9)
    v_mfma_f32_32x32x16_bf16 v[192:207], v[140:143], v[128:131], v[192:207]
    ds_read_b64_tr_b16 v[140:141], v14 offset:43808
    ds_read_b64_tr_b16 v[142:143], v14 offset:44448
    s_waitcnt lgkmcnt(9)
    v_mfma_f32_32x32x16_bf16 v[208:223], v[144:147], v[128:131], v[208:223]
    ds_read_b64_tr_b16 v[144:145], v14 offset:43840
    ds_read_b64_tr_b16 v[146:147], v14 offset:44480
    s_add_u32 m0, s72, 34816
    s_add_u32 s73, s58, 21120
    buffer_load_dwordx4 v16, s[28:31], s73 offen lds
    s_waitcnt lgkmcnt(9)
    v_mfma_f32_32x32x16_bf16 v[224:239], v[148:151], v[128:131], v[224:239]
    ds_read_b64_tr_b16 v[148:149], v14 offset:43872
    ds_read_b64_tr_b16 v[150:151], v14 offset:44512
    s_waitcnt lgkmcnt(9)
    v_mfma_f32_32x32x16_bf16 v[240:255], v[152:155], v[128:131], v[240:255]
    ds_read_b64_tr_b16 v[152:153], v14 offset:43904
    ds_read_b64_tr_b16 v[154:155], v14 offset:44544
    s_add_u32 m0, s72, 35840
    s_add_u32 s73, s58, 31360
    buffer_load_dwordx4 v17, s[28:31], s73 offen lds
    s_waitcnt lgkmcnt(8)
    v_mfma_f32_32x32x16_bf16 v[176:191], v[136:139], v[132:135], v[176:191]
    ds_read_b128 v[128:131], v12
    ds_read_b64_tr_b16 v[136:137], v14 offset:46336
    ds_read_b64_tr_b16 v[138:139], v14 offset:46976
    s_waitcnt lgkmcnt(9)
    v_mfma_f32_32x32x16_bf16 v[192:207], v[140:143], v[132:135], v[192:207]
    ds_read_b64_tr_b16 v[140:141], v14 offset:46368
    ds_read_b64_tr_b16 v[142:143], v14 offset:47008
    s_waitcnt lgkmcnt(9)
    v_mfma_f32_32x32x16_bf16 v[208:223], v[144:147], v[132:135], v[208:223]
    ds_read_b64_tr_b16 v[144:145], v14 offset:46400
    ds_read_b64_tr_b16 v[146:147], v14 offset:47040
    s_waitcnt lgkmcnt(9)
    v_mfma_f32_32x32x16_bf16 v[224:239], v[148:151], v[132:135], v[224:239]
    ds_read_b64_tr_b16 v[148:149], v14 offset:46432
    ds_read_b64_tr_b16 v[150:151], v14 offset:47072
    s_waitcnt lgkmcnt(9)
    v_mfma_f32_32x32x16_bf16 v[240:255], v[152:155], v[132:135], v[240:255]
    ds_read_b64_tr_b16 v[152:153], v14 offset:46464
    ds_read_b64_tr_b16 v[154:155], v14 offset:47104
    s_waitcnt lgkmcnt(8)
    v_mfma_f32_32x32x16_bf16 v[176:191], v[136:139], v[128:131], v[176:191]
    ds_read_b128 v[132:135], v13
    ds_read_b64_tr_b16 v[136:137], v14 offset:48896
    ds_read_b64_tr_b16 v[138:139], v14 offset:49536
    s_waitcnt lgkmcnt(9)
    v_mfma_f32_32x32x16_bf16 v[192:207], v[140:143], v[128:131], v[192:207]
    ds_read_b64_tr_b16 v[140:141], v14 offset:48928
    ds_read_b64_tr_b16 v[142:143], v14 offset:49568
    s_waitcnt lgkmcnt(9)
    v_mfma_f32_32x32x16_bf16 v[208:223], v[144:147], v[128:131], v[208:223]
    ds_read_b64_tr_b16 v[144:145], v14 offset:48960
    ds_read_b64_tr_b16 v[146:147], v14 offset:49600
    s_waitcnt lgkmcnt(9)
    v_mfma_f32_32x32x16_bf16 v[224:239], v[148:151], v[128:131], v[224:239]
    ds_read_b64_tr_b16 v[148:149], v14 offset:48992
    ds_read_b64_tr_b16 v[150:151], v14 offset:49632
    s_waitcnt lgkmcnt(9)
    v_mfma_f32_32x32x16_bf16 v[240:255], v[152:155], v[128:131], v[240:255]
    ds_read_b64_tr_b16 v[152:153], v14 offset:49024
    ds_read_b64_tr_b16 v[154:155], v14 offset:49664
    s_waitcnt vmcnt(9) lgkmcnt(0)
    s_barrier
    v_add_u32 v10, 0xffff0000, v10
    s_waitcnt lgkmcnt(8)
    v_mfma_f32_32x32x16_bf16 v[176:191], v[136:139], v[132:135], v[176:191]
    ds_read_b128 v[128:131], v10
    ds_read_b64_tr_b16 v[136:137], v14 offset:0
    ds_read_b64_tr_b16 v[138:139], v14 offset:640
    s_add_u32 m0, s71, 41216
    s_nop 0
    buffer_load_dwordx4 v18, s[32:35], s61 offen lds
    v_add_u32 v11, 0xffff0000, v11
    v_add_u32 v12, 0xffff0000, v12
    v_add_u32 v13, 0xffff0000, v13
    s_waitcnt lgkmcnt(9)
    v_mfma_f32_32x32x16_bf16 v[192:207], v[140:143], v[132:135], v[192:207]
    ds_read_b64_tr_b16 v[140:141], v14 offset:32
    ds_read_b64_tr_b16 v[142:143], v14 offset:672
    s_add_u32 m0, s72, 65536
    s_add_u32 s73, s58, 768
    buffer_load_dwordx4 v16, s[28:31], s73 offen lds
    s_waitcnt lgkmcnt(9)
    v_mfma_f32_32x32x16_bf16 v[208:223], v[144:147], v[132:135], v[208:223]
    ds_read_b64_tr_b16 v[144:145], v14 offset:64
    ds_read_b64_tr_b16 v[146:147], v14 offset:704
    s_add_u32 m0, s71, 45312
    s_nop 0
    buffer_load_dwordx4 v19, s[32:35], s61 offen lds
    s_waitcnt lgkmcnt(9)
    v_mfma_f32_32x32x16_bf16 v[224:239], v[148:151], v[132:135], v[224:239]
    ds_read_b64_tr_b16 v[148:149], v14 offset:96
    ds_read_b64_tr_b16 v[150:151], v14 offset:736
    s_waitcnt lgkmcnt(9)
    v_mfma_f32_32x32x16_bf16 v[240:255], v[152:155], v[132:135], v[240:255]
    ds_read_b64_tr_b16 v[152:153], v14 offset:128
    ds_read_b64_tr_b16 v[154:155], v14 offset:768
    s_add_u32 m0, s72, 66560
    s_add_u32 s73, s58, 11008
    buffer_load_dwordx4 v17, s[28:31], s73 offen lds
    s_waitcnt lgkmcnt(8)
    v_mfma_f32_32x32x16_bf16 v[176:191], v[136:139], v[128:131], v[176:191]
    ds_read_b128 v[132:135], v11
    ds_read_b64_tr_b16 v[136:137], v14 offset:2560
    ds_read_b64_tr_b16 v[138:139], v14 offset:3200
    s_add_u32 s74, s71, 49408
    s_cmp_lg_u32 s77, 0
    s_cselect_b32 m0, s74, 162816
    s_cselect_b32 s75, s61, s82
    buffer_load_dwordx4 v20, s[32:35], s75 offen lds
    s_add_u32 s61, s61, s76
    s_waitcnt lgkmcnt(9)
    v_mfma_f32_32x32x16_bf16 v[192:207], v[140:143], v[128:131], v[192:207]
    ds_read_b64_tr_b16 v[140:141], v14 offset:2592
    ds_read_b64_tr_b16 v[142:143], v14 offset:3232
    s_waitcnt lgkmcnt(9)
    v_mfma_f32_32x32x16_bf16 v[208:223], v[144:147], v[128:131], v[208:223]
    ds_read_b64_tr_b16 v[144:145], v14 offset:2624
    ds_read_b64_tr_b16 v[146:147], v14 offset:3264
    s_add_u32 m0, s72, 67584
    s_add_u32 s73, s58, 21248
    buffer_load_dwordx4 v16, s[28:31], s73 offen lds
    s_waitcnt lgkmcnt(9)
    v_mfma_f32_32x32x16_bf16 v[224:239], v[148:151], v[128:131], v[224:239]
    ds_read_b64_tr_b16 v[148:149], v14 offset:2656
    ds_read_b64_tr_b16 v[150:151], v14 offset:3296
    s_waitcnt lgkmcnt(9)
    v_mfma_f32_32x32x16_bf16 v[240:255], v[152:155], v[128:131], v[240:255]
    ds_read_b64_tr_b16 v[152:153], v14 offset:2688
    ds_read_b64_tr_b16 v[154:155], v14 offset:3328
    s_add_u32 m0, s72, 68608
    s_add_u32 s73, s58, 31488
    buffer_load_dwordx4 v17, s[28:31], s73 offen lds
    s_waitcnt lgkmcnt(8)
    v_mfma_f32_32x32x16_bf16 v[176:191], v[136:139], v[132:135], v[176:191]
    ds_read_b128 v[128:131], v12
    ds_read_b64_tr_b16 v[136:137], v14 offset:5120
    ds_read_b64_tr_b16 v[138:139], v14 offset:5760
    s_waitcnt lgkmcnt(9)
    v_mfma_f32_32x32x16_bf16 v[192:207], v[140:143], v[132:135], v[192:207]
    ds_read_b64_tr_b16 v[140:141], v14 offset:5152
    ds_read_b64_tr_b16 v[142:143], v14 offset:5792
    s_waitcnt lgkmcnt(9)
    v_mfma_f32_32x32x16_bf16 v[208:223], v[144:147], v[132:135], v[208:223]
    ds_read_b64_tr_b16 v[144:145], v14 offset:5184
    ds_read_b64_tr_b16 v[146:147], v14 offset:5824
    s_waitcnt lgkmcnt(9)
    v_mfma_f32_32x32x16_bf16 v[224:239], v[148:151], v[132:135], v[224:239]
    ds_read_b64_tr_b16 v[148:149], v14 offset:5216
    ds_read_b64_tr_b16 v[150:151], v14 offset:5856
    s_waitcnt lgkmcnt(9)
    v_mfma_f32_32x32x16_bf16 v[240:255], v[152:155], v[132:135], v[240:255]
    ds_read_b64_tr_b16 v[152:153], v14 offset:5248
    ds_read_b64_tr_b16 v[154:155], v14 offset:5888
    s_waitcnt lgkmcnt(8)
    v_mfma_f32_32x32x16_bf16 v[176:191], v[136:139], v[128:131], v[176:191]
    ds_read_b128 v[132:135], v13
    ds_read_b64_tr_b16 v[136:137], v14 offset:7680
    ds_read_b64_tr_b16 v[138:139], v14 offset:8320
    s_waitcnt lgkmcnt(9)
    v_mfma_f32_32x32x16_bf16 v[192:207], v[140:143], v[128:131], v[192:207]
    ds_read_b64_tr_b16 v[140:141], v14 offset:7712
    ds_read_b64_tr_b16 v[142:143], v14 offset:8352
    s_waitcnt lgkmcnt(9)
    v_mfma_f32_32x32x16_bf16 v[208:223], v[144:147], v[128:131], v[208:223]
    ds_read_b64_tr_b16 v[144:145], v14 offset:7744
    ds_read_b64_tr_b16 v[146:147], v14 offset:8384
    s_waitcnt lgkmcnt(9)
    v_mfma_f32_32x32x16_bf16 v[224:239], v[148:151], v[128:131], v[224:239]
    ds_read_b64_tr_b16 v[148:149], v14 offset:7776
    ds_read_b64_tr_b16 v[150:151], v14 offset:8416
    s_waitcnt lgkmcnt(9)
    v_mfma_f32_32x32x16_bf16 v[240:255], v[152:155], v[128:131], v[240:255]
    ds_read_b64_tr_b16 v[152:153], v14 offset:7808
    ds_read_b64_tr_b16 v[154:155], v14 offset:8448
    s_waitcnt vmcnt(7) lgkmcnt(0)
    s_barrier
    v_add_u32 v10, 0x8000, v10
    s_waitcnt lgkmcnt(8)
    v_mfma_f32_32x32x16_bf16 v[176:191], v[136:139], v[132:135], v[176:191]
    ds_read_b128 v[128:131], v10
    ds_read_b64_tr_b16 v[136:137], v14 offset:20608
    ds_read_b64_tr_b16 v[138:139], v14 offset:21248
    s_add_u32 m0, s71, 0
    s_nop 0
    buffer_load_dwordx4 v18, s[32:35], s61 offen lds
    v_add_u32 v11, 0x8000, v11
    v_add_u32 v12, 0x8000, v12
    v_add_u32 v13, 0x8000, v13
    s_waitcnt lgkmcnt(9)
    v_mfma_f32_32x32x16_bf16 v[192:207], v[140:143], v[132:135], v[192:207]
    ds_read_b64_tr_b16 v[140:141], v14 offset:20640
    ds_read_b64_tr_b16 v[142:143], v14 offset:21280
    s_add_u32 m0, s72, 0
    s_add_u32 s73, s58, 896
    buffer_load_dwordx4 v16, s[28:31], s73 offen lds
    s_cmp_eq_u32 s52, 0
    s_cbranch_scc0 L_w0_7
    v_and_b32 v2, 7, v1
    v_lshrrev_b32 v3, 1, v2
    v_lshlrev_b32 v3, 6, v3
    v_and_b32 v2, 1, v2
    v_lshl_add_u32 v2, v2, 2, v3
    buffer_load_dword v24, v2, s[40:43], 0 offen sc1
L_w0_7:
    s_waitcnt lgkmcnt(9)
    v_mfma_f32_32x32x16_bf16 v[208:223], v[144:147], v[132:135], v[208:223]
    ds_read_b64_tr_b16 v[144:145], v14 offset:20672
    ds_read_b64_tr_b16 v[146:147], v14 offset:21312
    s_add_u32 m0, s71, 4096
    s_nop 0
    buffer_load_dwordx4 v19, s[32:35], s61 offen lds
    s_waitcnt lgkmcnt(9)
    v_mfma_f32_32x32x16_bf16 v[224:239], v[148:151], v[132:135], v[224:239]
    ds_read_b64_tr_b16 v[148:149], v14 offset:20704
    ds_read_b64_tr_b16 v[150:151], v14 offset:21344
    s_waitcnt lgkmcnt(9)
    v_mfma_f32_32x32x16_bf16 v[240:255], v[152:155], v[132:135], v[240:255]
    ds_read_b64_tr_b16 v[152:153], v14 offset:20736
    ds_read_b64_tr_b16 v[154:155], v14 offset:21376
    s_add_u32 m0, s72, 1024
    s_add_u32 s73, s58, 11136
    buffer_load_dwordx4 v17, s[28:31], s73 offen lds
    s_waitcnt lgkmcnt(8)
    v_mfma_f32_32x32x16_bf16 v[176:191], v[136:139], v[128:131], v[176:191]
    ds_read_b128 v[132:135], v11
    ds_read_b64_tr_b16 v[136:137], v14 offset:23168
    ds_read_b64_tr_b16 v[138:139], v14 offset:23808
    s_add_u32 s74, s71, 8192
    s_cmp_lg_u32 s77, 0
    s_cselect_b32 m0, s74, 162816
    s_cselect_b32 s75, s61, s82
    buffer_load_dwordx4 v20, s[32:35], s75 offen lds
    s_add_u32 s61, s61, s76
    s_waitcnt lgkmcnt(9)
    v_mfma_f32_32x32x16_bf16 v[192:207], v[140:143], v[128:131], v[192:207]
    ds_read_b64_tr_b16 v[140:141], v14 offset:23200
    ds_read_b64_tr_b16 v[142:143], v14 offset:23840
    s_waitcnt lgkmcnt(9)
    v_mfma_f32_32x32x16_bf16 v[208:223], v[144:147], v[128:131], v[208:223]
    ds_read_b64_tr_b16 v[144:145], v14 offset:23232
    ds_read_b64_tr_b16 v[146:147], v14 offset:23872
    s_add_u32 m0, s72, 2048
    s_add_u32 s73, s58, 21376
    buffer_load_dwordx4 v16, s[28:31], s73 offen lds
    s_waitcnt lgkmcnt(9)
    v_mfma_f32_32x32x16_bf16 v[224:239], v[148:151], v[128:131], v[224:239]
    ds_read_b64_tr_b16 v[148:149], v14 offset:23264
    ds_read_b64_tr_b16 v[150:151], v14 offset:23904
    s_waitcnt lgkmcnt(9)
    v_mfma_f32_32x32x16_bf16 v[240:255], v[152:155], v[128:131], v[240:255]
    ds_read_b64_tr_b16 v[152:153], v14 offset:23296
    ds_read_b64_tr_b16 v[154:155], v14 offset:23936
    s_add_u32 m0, s72, 3072
    s_add_u32 s73, s58, 31616
    buffer_load_dwordx4 v17, s[28:31], s73 offen lds
    s_waitcnt lgkmcnt(8)
    v_mfma_f32_32x32x16_bf16 v[176:191], v[136:139], v[132:135], v[176:191]
    ds_read_b128 v[128:131], v12
    ds_read_b64_tr_b16 v[136:137], v14 offset:25728
    ds_read_b64_tr_b16 v[138:139], v14 offset:26368
    s_waitcnt lgkmcnt(9)
    v_mfma_f32_32x32x16_bf16 v[192:207], v[140:143], v[132:135], v[192:207]
    ds_read_b64_tr_b16 v[140:141], v14 offset:25760
    ds_read_b64_tr_b16 v[142:143], v14 offset:26400
    s_waitcnt lgkmcnt(9)
    v_mfma_f32_32x32x16_bf16 v[208:223], v[144:147], v[132:135], v[208:223]
    ds_read_b64_tr_b16 v[144:145], v14 offset:25792
    ds_read_b64_tr_b16 v[146:147], v14 offset:26432
    s_waitcnt lgkmcnt(9)
    v_mfma_f32_32x32x16_bf16 v[224:239], v[148:151], v[132:135], v[224:239]
    ds_read_b64_tr_b16 v[148:149], v14 offset:25824
    ds_read_b64_tr_b16 v[150:151], v14 offset:26464
    s_waitcnt lgkmcnt(9)
    v_mfma_f32_32x32x16_bf16 v[240:255], v[152:155], v[132:135], v[240:255]
    ds_read_b64_tr_b16 v[152:153], v14 offset:25856
    ds_read_b64_tr_b16 v[154:155], v14 offset:26496
    s_waitcnt lgkmcnt(8)
    v_mfma_f32_32x32x16_bf16 v[176:191], v[136:139], v[128:131], v[176:191]
    ds_read_b128 v[132:135], v13
    ds_read_b64_tr_b16 v[136:137], v14 offset:28288
    ds_read_b64_tr_b16 v[138:139], v14 offset:28928
    s_waitcnt lgkmcnt(9)
    v_mfma_f32_32x32x16_bf16 v[192:207], v[140:143], v[128:131], v[192:207]
    ds_read_b64_tr_b16 v[140:141], v14 offset:28320
    ds_read_b64_tr_b16 v[142:143], v14 offset:28960
    s_waitcnt lgkmcnt(9)
    v_mfma_f32_32x32x16_bf16 v[208:223], v[144:147], v[128:131], v[208:223]
    ds_read_b64_tr_b16 v[144:145], v14 offset:28352
    ds_read_b64_tr_b16 v[146:147], v14 offset:28992
    s_waitcnt lgkmcnt(9)
    v_mfma_f32_32x32x16_bf16 v[224:239], v[148:151], v[128:131], v[224:239]
    ds_read_b64_tr_b16 v[148:149], v14 offset:28384
    ds_read_b64_tr_b16 v[150:151], v14 offset:29024
    s_waitcnt lgkmcnt(9)
    v_mfma_f32_32x32x16_bf16 v[240:255], v[152:155], v[128:131], v[240:255]
    ds_read_b64_tr_b16 v[152:153], v14 offset:28416
    ds_read_b64_tr_b16 v[154:155], v14 offset:29056
    s_waitcnt vmcnt(7) lgkmcnt(0)
    s_cmp_eq_u32 s52, 0
    s_cbranch_scc0 L_w0_8
    s_waitcnt vmcnt(5)
    s_mov_b32 s78, 0
L_spin_9:
    v_cmp_gt_u32 vcc, 32, v24
    s_nop 4
    s_cmp_eq_u64 vcc, 0
    s_cbranch_scc1 L_spind_10
    s_add_u32 s78, s78, 1
    s_cmp_gt_u32 s78, 200000
    s_cbranch_scc1 L_spind_10
    s_sleep 2
    v_and_b32 v2, 7, v1
    v_lshrrev_b32 v3, 1, v2
    v_lshlrev_b32 v3, 6, v3
    v_and_b32 v2, 1, v2
    v_lshl_add_u32 v2, v2, 2, v3
    buffer_load_dword v24, v2, s[40:43], 0 offen sc1
    s_waitcnt vmcnt(0)
    s_branch L_spin_9
L_spind_10:
L_w0_8:
    s_barrier
    v_add_u32 v10, 0x8000, v10
    s_waitcnt lgkmcnt(8)
    v_mfma_f32_32x32x16_bf16 v[176:191], v[136:139], v[132:135], v[176:191]
    ds_read_b128 v[128:131], v10
    ds_read_b64_tr_b16 v[136:137], v14 offset:41216
    ds_read_b64_tr_b16 v[138:139], v14 offset:41856
    v_add_u32 v11, 0x8000, v11
    v_add_u32 v12, 0x8000, v12
    v_add_u32 v13, 0x8000, v13
    s_waitcnt lgkmcnt(9)
    v_mfma_f32_32x32x16_bf16 v[192:207], v[140:143], v[132:135], v[192:207]
    ds_read_b64_tr_b16 v[140:141], v14 offset:41248
    ds_read_b64_tr_b16 v[142:143], v14 offset:41888
    v_and_b32 v2, 31, v1
    v_lshlrev_b32 v3, 3, v2
    s_lshl_b32 s78, s53, 8
    s_waitcnt lgkmcnt(9)
    v_mfma_f32_32x32x16_bf16 v[208:223], v[144:147], v[132:135], v[208:223]
    ds_read_b64_tr_b16 v[144:145], v14 offset:41280
    ds_read_b64_tr_b16 v[146:147], v14 offset:41920
    s_lshl_b32 s60, s52, 5
    s_add_u32 s78, s78, s60
    s_lshl_b32 s78, s78, 3
    s_waitcnt lgkmcnt(9)
    v_mfma_f32_32x32x16_bf16 v[224:239], v[148:151], v[132:135], v[224:239]
    ds_read_b64_tr_b16 v[148:149], v14 offset:41312
    ds_read_b64_tr_b16 v[150:151], v14 offset:41952
    s_add_u32 s78, s78, 9043968
    buffer_load_dwordx2 v[22:23], v3, s[36:39], s78 offen sc1
    v_lshlrev_b32 v3, 2, v2
    s_waitcnt lgkmcnt(9)
    v_mfma_f32_32x32x16_bf16 v[240:255], v[152:155], v[132:135], v[240:255]
    ds_read_b64_tr_b16 v[152:153], v14 offset:41344
    ds_read_b64_tr_b16 v[154:155], v14 offset:41984
    s_mul_i32 s78, s56, 5120
    s_min_u32 s60, s52, 4
    s_lshl_b32 s60, s60, 7
    s_waitcnt lgkmcnt(8)
    v_mfma_f32_32x32x16_bf16 v[176:191], v[136:139], v[128:131], v[176:191]
    ds_read_b128 v[132:135], v11
    ds_read_b64_tr_b16 v[136:137], v14 offset:43776
    ds_read_b64_tr_b16 v[138:139], v14 offset:44416
    s_add_u32 s78, s78, s60
    s_add_u32 s78, s78, 9066496
    buffer_load_dword v64, v3, s[36:39], s78 offen offset:0 sc1
    s_waitcnt lgkmcnt(9)
    v_mfma_f32_32x32x16_bf16 v[192:207], v[140:143], v[128:131], v[192:207]
    ds_read_b64_tr_b16 v[140:141], v14 offset:43808
    ds_read_b64_tr_b16 v[142:143], v14 offset:44448
    buffer_load_dword v65, v3, s[36:39], s78 offen offset:640 sc1
    buffer_load_dword v66, v3, s[36:39], s78 offen offset:1280 sc1
    buffer_load_dword v67, v3, s[36:39], s78 offen offset:1920 sc1
    s_waitcnt lgkmcnt(9)
    v_mfma_f32_32x32x16_bf16 v[208:223], v[144:147], v[128:131], v[208:223]
    ds_read_b64_tr_b16 v[144:145], v14 offset:43840
    ds_read_b64_tr_b16 v[146:147], v14 offset:44480
    buffer_load_dword v68, v3, s[36:39], s78 offen offset:2560 sc1
    buffer_load_dword v69, v3, s[36:39], s78 offen offset:3200 sc1
    buffer_load_dword v70, v3, s[36:39], s78 offen offset:3840 sc1
    s_waitcnt lgkmcnt(9)
    v_mfma_f32_32x32x16_bf16 v[224:239], v[148:151], v[128:131], v[224:239]
    ds_read_b64_tr_b16 v[148:149], v14 offset:43872
    ds_read_b64_tr_b16 v[150:151], v14 offset:44512
    s_add_u32 s60, s78, 4480
    buffer_load_dword v71, v3, s[36:39], s60 offen sc1
    s_waitcnt lgkmcnt(9)
    v_mfma_f32_32x32x16_bf16 v[240:255], v[152:155], v[128:131], v[240:255]
    ds_read_b64_tr_b16 v[152:153], v14 offset:43904
    ds_read_b64_tr_b16 v[154:155], v14 offset:44544
    s_waitcnt lgkmcnt(8)
    v_mfma_f32_32x32x16_bf16 v[176:191], v[136:139], v[132:135], v[176:191]
    ds_read_b128 v[128:131], v12
    ds_read_b64_tr_b16 v[136:137], v14 offset:46336
    ds_read_b64_tr_b16 v[138:139], v14 offset:46976
    s_waitcnt lgkmcnt(9)
    v_mfma_f32_32x32x16_bf16 v[192:207], v[140:143], v[132:135], v[192:207]
    ds_read_b64_tr_b16 v[140:141], v14 offset:46368
    ds_read_b64_tr_b16 v[142:143], v14 offset:47008
    s_waitcnt lgkmcnt(9)
    v_mfma_f32_32x32x16_bf16 v[208:223], v[144:147], v[132:135], v[208:223]
    ds_read_b64_tr_b16 v[144:145], v14 offset:46400
    ds_read_b64_tr_b16 v[146:147], v14 offset:47040
    s_waitcnt lgkmcnt(9)
    v_mfma_f32_32x32x16_bf16 v[224:239], v[148:151], v[132:135], v[224:239]
    ds_read_b64_tr_b16 v[148:149], v14 offset:46432
    ds_read_b64_tr_b16 v[150:151], v14 offset:47072
    s_waitcnt lgkmcnt(9)
    v_mfma_f32_32x32x16_bf16 v[240:255], v[152:155], v[132:135], v[240:255]
    ds_read_b64_tr_b16 v[152:153], v14 offset:46464
    ds_read_b64_tr_b16 v[154:155], v14 offset:47104
    s_waitcnt lgkmcnt(8)
    v_mfma_f32_32x32x16_bf16 v[176:191], v[136:139], v[128:131], v[176:191]
    ds_read_b128 v[132:135], v13
    ds_read_b64_tr_b16 v[136:137], v14 offset:48896
    ds_read_b64_tr_b16 v[138:139], v14 offset:49536
    s_waitcnt lgkmcnt(9)
    v_mfma_f32_32x32x16_bf16 v[192:207], v[140:143], v[128:131], v[192:207]
    ds_read_b64_tr_b16 v[140:141], v14 offset:48928
    ds_read_b64_tr_b16 v[142:143], v14 offset:49568
    s_waitcnt lgkmcnt(9)
    v_mfma_f32_32x32x16_bf16 v[208:223], v[144:147], v[128:131], v[208:223]
    ds_read_b64_tr_b16 v[144:145], v14 offset:48960
    ds_read_b64_tr_b16 v[146:147], v14 offset:49600
    s_waitcnt lgkmcnt(9)
    v_mfma_f32_32x32x16_bf16 v[224:239], v[148:151], v[128:131], v[224:239]
    ds_read_b64_tr_b16 v[148:149], v14 offset:48992
    ds_read_b64_tr_b16 v[150:151], v14 offset:49632
    s_waitcnt lgkmcnt(9)
    v_mfma_f32_32x32x16_bf16 v[240:255], v[152:155], v[128:131], v[240:255]
    ds_read_b64_tr_b16 v[152:153], v14 offset:49024
    ds_read_b64_tr_b16 v[154:155], v14 offset:49664
    s_waitcnt vmcnt(0) lgkmcnt(0)
    s_barrier
    v_add_u32 v10, 0xffff0000, v10
    s_waitcnt lgkmcnt(8)
    v_mfma_f32_32x32x16_bf16 v[176:191], v[136:139], v[132:135], v[176:191]
    ds_read_b128 v[128:131], v10
    ds_read_b64_tr_b16 v[136:137], v14 offset:0
    ds_read_b64_tr_b16 v[138:139], v14 offset:640
    v_add_u32 v11, 0xffff0000, v11
    v_add_u32 v12, 0xffff0000, v12
    v_add_u32 v13, 0xffff0000, v13
    s_waitcnt lgkmcnt(9)
    v_mfma_f32_32x32x16_bf16 v[192:207], v[140:143], v[132:135], v[192:207]
    ds_read_b64_tr_b16 v[140:141], v14 offset:32
    ds_read_b64_tr_b16 v[142:143], v14 offset:672
    v_rsq_f32 v24, v23
    v_sub_f32 v2, 0, v22
    v_cvt_pk_bf16_f32 v60, v2, v2
    s_waitcnt lgkmcnt(9)
    v_mfma_f32_32x32x16_bf16 v[208:223], v[144:147], v[132:135], v[208:223]
    ds_read_b64_tr_b16 v[144:145], v14 offset:64
    ds_read_b64_tr_b16 v[146:147], v14 offset:704
    v_and_b32 v3, s68, v60
    v_sub_f32 v3, v2, v3
    v_cvt_pk_bf16_f32 v61, v3, 0
    s_waitcnt lgkmcnt(9)
    v_mfma_f32_32x32x16_bf16 v[224:239], v[148:151], v[132:135], v[224:239]
    ds_read_b64_tr_b16 v[148:149], v14 offset:96
    ds_read_b64_tr_b16 v[150:151], v14 offset:736
    v_mov_b32 v62, 0
    v_mov_b32 v63, 0
    v_add_f32 v64, v64, v65
    s_waitcnt lgkmcnt(9)
    v_mfma_f32_32x32x16_bf16 v[240:255], v[152:155], v[132:135], v[240:255]
    ds_read_b64_tr_b16 v[152:153], v14 offset:128
    ds_read_b64_tr_b16 v[154:155], v14 offset:768
    v_add_f32 v66, v66, v67
    v_add_f32 v68, v68, v69
    v_add_f32 v70, v70, v71
    s_waitcnt lgkmcnt(8)
    v_mfma_f32_32x32x16_bf16 v[176:191], v[136:139], v[128:131], v[176:191]
    ds_read_b128 v[132:135], v11
    ds_read_b64_tr_b16 v[136:137], v14 offset:2560
    ds_read_b64_tr_b16 v[138:139], v14 offset:3200
    v_add_f32 v64, v64, v66
    v_add_f32 v68, v68, v70
    v_add_f32 v64, v64, v68
    s_waitcnt lgkmcnt(9)
    v_mfma_f32_32x32x16_bf16 v[192:207], v[140:143], v[128:131], v[192:207]
    ds_read_b64_tr_b16 v[140:141], v14 offset:2592
    ds_read_b64_tr_b16 v[142:143], v14 offset:3232
    v_cvt_pk_bf16_f32 v5, v64, 0
    v_lshlrev_b32 v2, 16, v5
    v_sub_f32 v2, v64, v2
    s_waitcnt lgkmcnt(9)
    v_mfma_f32_32x32x16_bf16 v[208:223], v[144:147], v[128:131], v[208:223]
    ds_read_b64_tr_b16 v[144:145], v14 offset:2624
    ds_read_b64_tr_b16 v[146:147], v14 offset:3264
    v_cvt_pk_bf16_f32 v4, v64, v2
    v_lshlrev_b32 v6, 3, v1
    s_lshl_b32 s78, s52, 8
    s_waitcnt lgkmcnt(9)
    v_mfma_f32_32x32x16_bf16 v[224:239], v[148:151], v[128:131], v[224:239]
    ds_read_b64_tr_b16 v[148:149], v14 offset:2656
    ds_read_b64_tr_b16 v[150:151], v14 offset:3296
    s_add_u32 s78, s78, 160256
    v_add_u32 v6, s78, v6
    v_mov_b32 v7, 162816
    s_waitcnt lgkmcnt(9)
    v_mfma_f32_32x32x16_bf16 v[240:255], v[152:155], v[128:131], v[240:255]
    ds_read_b64_tr_b16 v[152:153], v14 offset:2688
    ds_read_b64_tr_b16 v[154:155], v14 offset:3328
    v_cmp_gt_u32 vcc, 32, v1
    s_nop 1
    v_cndmask_b32 v6, v7, v6, vcc
    s_cmp_ge_u32 s52, 5
    s_cselect_b64 vcc, -1, 0
    s_waitcnt lgkmcnt(8)
    v_mfma_f32_32x32x16_bf16 v[176:191], v[136:139], v[132:135], v[176:191]
    ds_read_b128 v[128:131], v12
    ds_read_b64_tr_b16 v[136:137], v14 offset:5120
    ds_read_b64_tr_b16 v[138:139], v14 offset:5760
    v_cndmask_b32 v6, v6, v7, vcc
    ds_write_b64 v6, v[4:5]
    v_lshl_or_b32 v52, v105, 16, v104
    s_waitcnt lgkmcnt(9)
    v_mfma_f32_32x32x16_bf16 v[192:207], v[140:143], v[132:135], v[192:207]
    ds_read_b64_tr_b16 v[140:141], v14 offset:5152
    ds_read_b64_tr_b16 v[142:143], v14 offset:5792
    v_lshl_or_b32 v53, v107, 16, v106
    v_lshl_or_b32 v54, v109, 16, v108
    v_lshl_or_b32 v55, v111, 16, v110
    s_waitcnt lgkmcnt(9)
    v_mfma_f32_32x32x16_bf16 v[208:223], v[144:147], v[132:135], v[208:223]
    ds_read_b64_tr_b16 v[144:145], v14 offset:5184
    ds_read_b64_tr_b16 v[146:147], v14 offset:5824
    v_lshl_or_b32 v56, v113, 16, v112
    v_lshl_or_b32 v57, v115, 16, v114
    v_lshl_or_b32 v58, v117, 16, v116
    s_waitcnt lgkmcnt(9)
    v_mfma_f32_32x32x16_bf16 v[224:239], v[148:151], v[132:135], v[224:239]
    ds_read_b64_tr_b16 v[148:149], v14 offset:5216
    ds_read_b64_tr_b16 v[150:151], v14 offset:5856
    v_lshl_or_b32 v59, v119, 16, v118
    v_lshlrev_b32 v6, 4, v1
    s_lshl_b32 s78, s52, 10
    s_waitcnt lgkmcnt(9)
    v_mfma_f32_32x32x16_bf16 v[240:255], v[152:155], v[132:135], v[240:255]
    ds_read_b64_tr_b16 v[152:153], v14 offset:5248
    ds_read_b64_tr_b16 v[154:155], v14 offset:5888
    s_add_u32 s78, s78, 122880
    v_add_u32 v6, s78, v6
    ds_write_b128 v6, v[52:55]
    s_waitcnt lgkmcnt(8)
    v_mfma_f32_32x32x16_bf16 v[176:191], v[136:139], v[128:131], v[176:191]
    ds_read_b128 v[132:135], v13
    ds_read_b64_tr_b16 v[136:137], v14 offset:7680
    ds_read_b64_tr_b16 v[138:139], v14 offset:8320
    ds_write_b128 v6, v[56:59] offset:8192
    s_waitcnt lgkmcnt(9)
    v_mfma_f32_32x32x16_bf16 v[192:207], v[140:143], v[128:131], v[192:207]
    ds_read_b64_tr_b16 v[140:141], v14 offset:7712
    ds_read_b64_tr_b16 v[142:143], v14 offset:8352
    s_waitcnt lgkmcnt(9)
    v_mfma_f32_32x32x16_bf16 v[208:223], v[144:147], v[128:131], v[208:223]
    ds_read_b64_tr_b16 v[144:145], v14 offset:7744
    ds_read_b64_tr_b16 v[146:147], v14 offset:8384
    s_waitcnt lgkmcnt(9)
    v_mfma_f32_32x32x16_bf16 v[224:239], v[148:151], v[128:131], v[224:239]
    ds_read_b64_tr_b16 v[148:149], v14 offset:7776
    ds_read_b64_tr_b16 v[150:151], v14 offset:8416
    s_waitcnt lgkmcnt(9)
    v_mfma_f32_32x32x16_bf16 v[240:255], v[152:155], v[128:131], v[240:255]
    ds_read_b64_tr_b16 v[152:153], v14 offset:7808
    ds_read_b64_tr_b16 v[154:155], v14 offset:8448
    s_waitcnt vmcnt(63) lgkmcnt(0)
    s_barrier
    s_waitcnt lgkmcnt(8)
    v_mfma_f32_32x32x16_bf16 v[176:191], v[136:139], v[132:135], v[176:191]
    v_lshlrev_b32 v6, 3, v1
    v_add_u32 v6, 160256, v6
    v_mov_b32 v7, 160128
    s_waitcnt lgkmcnt(6)
    v_mfma_f32_32x32x16_bf16 v[192:207], v[140:143], v[132:135], v[192:207]
    v_cmp_gt_u32 vcc, 32, v1
    s_nop 1
    v_cndmask_b32 v8, v7, v6, vcc
    v_mov_b32 v9, 256
    s_waitcnt lgkmcnt(4)
    v_mfma_f32_32x32x16_bf16 v[208:223], v[144:147], v[132:135], v[208:223]
    v_cndmask_b32 v9, 0, v9, vcc
    ds_read_b64 v[32:33], v8
    v_add_u32 v8, v8, v9
    s_waitcnt lgkmcnt(2)
    v_mfma_f32_32x32x16_bf16 v[224:239], v[148:151], v[132:135], v[224:239]
    ds_read_b64 v[36:37], v8
    v_add_u32 v8, v8, v9
    ds_read_b64 v[40:41], v8
    s_waitcnt lgkmcnt(0)
    v_mfma_f32_32x32x16_bf16 v[240:255], v[152:155], v[132:135], v[240:255]
    v_add_u32 v8, v8, v9
    ds_read_b64 v[44:45], v8
    v_add_u32 v8, v8, v9
    ds_read_b64 v[48:49], v8
    s_waitcnt lgkmcnt(0)
    v_mfma_f32_32x32x16_bf16 v[176:191], v[32:35], v[60:63], v[176:191]
    v_mfma_f32_32x32x16_bf16 v[192:207], v[36:39], v[60:63], v[192:207]
    v_mfma_f32_32x32x16_bf16 v[208:223], v[40:43], v[60:63], v[208:223]
    v_mfma_f32_32x32x16_bf16 v[224:239], v[44:47], v[60:63], v[224:239]
    v_mfma_f32_32x32x16_bf16 v[240:255], v[48:51], v[60:63], v[240:255]
    s_cmp_eq_u32 s54, 2
    s_cbranch_scc1 L_ffn
    s_cmp_eq_u32 s54, 1
    s_cbranch_scc1 L_q
    v_mul_f32 v25, 0x3fb8aa3b, v24
    ds_read_b128 v[40:43], v172 offset:0
    ds_read_b128 v[44:47], v172 offset:1024
    ds_read_b128 v[48:51], v172 offset:2048
    ds_read_b128 v[52:55], v172 offset:3072
    v_cvt_pk_bf16_f32 v64, v176, v177
    v_cvt_pk_bf16_f32 v65, v178, v179
    v_cvt_pk_bf16_f32 v66, v180, v181
    v_cvt_pk_bf16_f32 v67, v182, v183
    v_cvt_pk_bf16_f32 v68, v192, v193
    v_cvt_pk_bf16_f32 v69, v194, v195
    v_cvt_pk_bf16_f32 v70, v196, v197
    v_cvt_pk_bf16_f32 v71, v198, v199
    v_cvt_pk_bf16_f32 v72, v208, v209
    v_cvt_pk_bf16_f32 v73, v210, v211
    v_cvt_pk_bf16_f32 v74, v212, v213
    v_cvt_pk_bf16_f32 v75, v214, v215
    v_cvt_pk_bf16_f32 v76, v224, v225
    v_cvt_pk_bf16_f32 v77, v226, v227
    v_cvt_pk_bf16_f32 v78, v228, v229
    v_cvt_pk_bf16_f32 v79, v230, v231
    v_cvt_pk_bf16_f32 v80, v240, v241
    v_cvt_pk_bf16_f32 v81, v242, v243
    v_cvt_pk_bf16_f32 v82, v244, v245
    v_cvt_pk_bf16_f32 v83, v246, v247
    v_mov_b32 v84, 0
    v_mov_b32 v85, 0
    s_waitcnt lgkmcnt(0)
    v_mfma_f32_32x32x16_bf16 v[104:119], v[40:43], v[64:67], 0
    v_mfma_f32_32x32x16_bf16 v[104:119], v[44:47], v[68:71], v[104:119]
    v_mfma_f32_32x32x16_bf16 v[120:135], v[48:51], v[68:71], 0
    v_mfma_f32_32x32x16_bf16 v[120:135], v[52:55], v[72:75], v[120:135]
    ds_read_b128 v[40:43], v172 offset:4096
    ds_read_b128 v[44:47], v172 offset:5120
    ds_read_b128 v[48:51], v172 offset:6144
    ds_read_b128 v[52:55], v172 offset:7168
    s_barrier
    v_mul_f32 v184, v184, v24
    v_mul_f32 v185, v185, v24
    v_mul_f32 v186, v186, v24
    v_mul_f32 v187, v187, v24
    v_cvt_pk_bf16_f32 v162, v184, v185
    v_cvt_pk_bf16_f32 v163, v186, v187
    ds_write_b64 v171, v[162:163] offset:0
    v_mul_f32 v188, v188, v24
    v_mul_f32 v189, v189, v24
    v_mul_f32 v190, v190, v24
    v_mul_f32 v191, v191, v24
    v_cvt_pk_bf16_f32 v162, v188, v189
    v_cvt_pk_bf16_f32 v163, v190, v191
    ds_write_b64 v171, v[162:163] offset:16
    v_mul_f32 v200, v200, v24
    v_mul_f32 v201, v201, v24
    v_mul_f32 v202, v202, v24
    v_mul_f32 v203, v203, v24
    v_cvt_pk_bf16_f32 v162, v200, v201
    v_cvt_pk_bf16_f32 v163, v202, v203
    ds_write_b64 v171, v[162:163] offset:32
    v_mul_f32 v204, v204, v24
    v_mul_f32 v205, v205, v24
    v_mul_f32 v206, v206, v24
    v_mul_f32 v207, v207, v24
    v_cvt_pk_bf16_f32 v162, v204, v205
    v_cvt_pk_bf16_f32 v163, v206, v207
    ds_write_b64 v171, v[162:163] offset:48
    v_mul_f32 v216, v216, v24
    v_mul_f32 v217, v217, v24
    v_mul_f32 v218, v218, v24
    v_mul_f32 v219, v219, v24
    v_cvt_pk_bf16_f32 v162, v216, v217
    v_cvt_pk_bf16_f32 v163, v218, v219
    ds_write_b64 v171, v[162:163] offset:64
    v_mul_f32 v220, v220, v24
    v_mul_f32 v221, v221, v24
    v_mul_f32 v222, v222, v24
    v_mul_f32 v223, v223, v24
    v_cvt_pk_bf16_f32 v162, v220, v221
    v_cvt_pk_bf16_f32 v163, v222, v223
    ds_write_b64 v171, v[162:163] offset:80
    v_mul_f32 v232, v232, v24
    v_mul_f32 v233, v233, v24
    v_mul_f32 v234, v234, v24
    v_mul_f32 v235, v235, v24
    v_cvt_pk_bf16_f32 v162, v232, v233
    v_cvt_pk_bf16_f32 v163, v234, v235
    ds_write_b64 v171, v[162:163] offset:96
    v_mul_f32 v236, v236, v24
    v_mul_f32 v237, v237, v24
    v_mul_f32 v238, v238, v24
    v_mul_f32 v239, v239, v24
    v_cvt_pk_bf16_f32 v162, v236, v237
    v_cvt_pk_bf16_f32 v163, v238, v239
    ds_write_b64 v171, v[162:163] offset:112
    v_mul_f32 v248, v248, v24
    v_mul_f32 v249, v249, v24
    v_mul_f32 v250, v250, v24
    v_mul_f32 v251, v251, v24
    v_cvt_pk_bf16_f32 v162, v248, v249
    v_cvt_pk_bf16_f32 v163, v250, v251
    ds_write_b64 v171, v[162:163] offset:128
    v_mul_f32 v252, v252, v24
    v_mul_f32 v253, v253, v24
    v_mul_f32 v254, v254, v24
    v_mul_f32 v255, v255, v24
    v_cvt_pk_bf16_f32 v162, v252, v253
    v_cvt_pk_bf16_f32 v163, v254, v255
    ds_write_b64 v171, v[162:163] offset:144
    v_max3_f32 v156, v104, v105, v106
    v_min3_f32 v157, v104, v105, v106
    v_max3_f32 v156, v156, v107, v108
    v_min3_f32 v157, v157, v107, v108
    v_max3_f32 v156, v156, v109, v110
    v_min3_f32 v157, v157, v109, v110
    v_max3_f32 v156, v156, v111, v112
    v_min3_f32 v157, v157, v111, v112
    v_max_f32 v156, v156, v113
    v_min_f32 v157, v157, v113
    v_mov_b32 v158, v156
    v_mov_b32 v159, v157
    s_nop 0
    v_permlane32_swap_b32 v156, v158
    v_permlane32_swap_b32 v157, v159
    v_max_f32 v156, v156, v158
    v_min_f32 v157, v157, v159
    v_mul_f32 v156, v156, v25
    v_mul_f32 v157, v157, v25
    v_fma_f32 v136, v104, v25, -v156
    v_fma_f32 v146, -v104, v25, v157
    v_fma_f32 v137, v105, v25, -v156
    v_fma_f32 v147, -v105, v25, v157
    v_fma_f32 v138, v106, v25, -v156
    v_fma_f32 v148, -v106, v25, v157
    v_fma_f32 v139, v107, v25, -v156
    v_fma_f32 v149, -v107, v25, v157
    v_fma_f32 v140, v108, v25, -v156
    v_fma_f32 v150, -v108, v25, v157
    v_fma_f32 v141, v109, v25, -v156
    v_fma_f32 v151, -v109, v25, v157
    v_fma_f32 v142, v110, v25, -v156
    v_fma_f32 v152, -v110, v25, v157
    v_fma_f32 v143, v111, v25, -v156
    v_fma_f32 v153, -v111, v25, v157
    v_fma_f32 v144, v112, v25, -v156
    v_fma_f32 v154, -v112, v25, v157
    v_fma_f32 v145, v113, v25, -v156
    v_fma_f32 v155, -v113, v25, v157
    v_exp_f32 v136, v136
    v_exp_f32 v137, v137
    v_exp_f32 v138, v138
    v_exp_f32 v139, v139
    v_exp_f32 v140, v140
    v_exp_f32 v141, v141
    v_exp_f32 v142, v142
    v_exp_f32 v143, v143
    v_exp_f32 v144, v144
    v_exp_f32 v145, v145
    v_exp_f32 v146, v146
    v_exp_f32 v147, v147
    v_exp_f32 v148, v148
    v_exp_f32 v149, v149
    v_exp_f32 v150, v150
    v_exp_f32 v151, v151
    v_exp_f32 v152, v152
    v_exp_f32 v153, v153
    v_exp_f32 v154, v154
    v_exp_f32 v155, v155
    v_add_f32 v160, v136, v137
    v_add_f32 v161, v146, v147
    v_add_f32 v160, v160, v138
    v_add_f32 v161, v161, v148
    v_add_f32 v160, v160, v139
    v_add_f32 v161, v161, v149
    v_add_f32 v160, v160, v140
    v_add_f32 v161, v161, v150
    v_add_f32 v160, v160, v141
    v_add_f32 v161, v161, v151
    v_add_f32 v160, v160, v142
    v_add_f32 v161, v161, v152
    v_add_f32 v160, v160, v143
    v_add_f32 v161, v161, v153
    v_add_f32 v160, v160, v144
    v_add_f32 v161, v161, v154
    v_add_f32 v160, v160, v145
    v_add_f32 v161, v161, v155
    v_mov_b32 v158, v160
    v_mov_b32 v159, v161
    s_nop 0
    v_permlane32_swap_b32 v160, v158
    v_permlane32_swap_b32 v161, v159
    v_add_f32 v160, v160, v158
    v_add_f32 v161, v161, v159
    v_rcp_f32 v160, v160
    v_rcp_f32 v161, v161
    v_mul_f32 v136, v136, v160
    v_mul_f32 v146, v146, v161
    v_mul_f32 v137, v137, v160
    v_mul_f32 v147, v147, v161
    v_mul_f32 v138, v138, v160
    v_mul_f32 v148, v148, v161
    v_mul_f32 v139, v139, v160
    v_mul_f32 v149, v149, v161
    v_mul_f32 v140, v140, v160
    v_mul_f32 v150, v150, v161
    v_mul_f32 v141, v141, v160
    v_mul_f32 v151, v151, v161
    v_mul_f32 v142, v142, v160
    v_mul_f32 v152, v152, v161
    v_mul_f32 v143, v143, v160
    v_mul_f32 v153, v153, v161
    v_mul_f32 v144, v144, v160
    v_mul_f32 v154, v154, v161
    v_mul_f32 v145, v145, v160
    v_mul_f32 v155, v155, v161
    v_cvt_pk_bf16_f32 v88, v136, v137
    v_cvt_pk_bf16_f32 v89, v138, v139
    v_cvt_pk_bf16_f32 v90, v140, v141
    v_cvt_pk_bf16_f32 v91, v142, v143
    v_cvt_pk_bf16_f32 v92, v144, v145
    v_cvt_pk_bf16_f32 v93, v146, v147
    v_cvt_pk_bf16_f32 v94, v148, v149
    v_cvt_pk_bf16_f32 v95, v150, v151
    v_cvt_pk_bf16_f32 v96, v152, v153
    v_cvt_pk_bf16_f32 v97, v154, v155
    s_waitcnt lgkmcnt(0)
    v_mfma_f32_32x32x16_bf16 v[104:119], v[40:43], v[74:77], 0
    v_mfma_f32_32x32x16_bf16 v[104:119], v[44:47], v[78:81], v[104:119]
    ds_write_b64 v170, v[88:89] offset:0
    ds_write_b64 v170, v[90:91] offset:8
    ds_write_b64 v170, v[92:93] offset:16
    ds_write_b64 v170, v[94:95] offset:24
    ds_write_b64 v170, v[96:97] offset:32
    v_max3_f32 v156, v120, v121, v122
    v_min3_f32 v157, v120, v121, v122
    v_max3_f32 v156, v156, v123, v124
    v_min3_f32 v157, v157, v123, v124
    v_max3_f32 v156, v156, v125, v126
    v_min3_f32 v157, v157, v125, v126
    v_max3_f32 v156, v156, v127, v128
    v_min3_f32 v157, v157, v127, v128
    v_max_f32 v156, v156, v129
    v_min_f32 v157, v157, v129
    v_mov_b32 v158, v156
    v_mov_b32 v159, v157
    s_nop 0
    v_permlane32_swap_b32 v156, v158
    v_permlane32_swap_b32 v157, v159
    v_max_f32 v156, v156, v158
    v_min_f32 v157, v157, v159
    v_mul_f32 v156, v156, v25
    v_mul_f32 v157, v157, v25
    v_fma_f32 v136, v120, v25, -v156
    v_fma_f32 v146, -v120, v25, v157
    v_fma_f32 v137, v121, v25, -v156
    v_fma_f32 v147, -v121, v25, v157
    v_fma_f32 v138, v122, v25, -v156
    v_fma_f32 v148, -v122, v25, v157
    v_fma_f32 v139, v123, v25, -v156
    v_fma_f32 v149, -v123, v25, v157
    v_fma_f32 v140, v124, v25, -v156
    v_fma_f32 v150, -v124, v25, v157
    v_fma_f32 v141, v125, v25, -v156
    v_fma_f32 v151, -v125, v25, v157
    v_fma_f32 v142, v126, v25, -v156
    v_fma_f32 v152, -v126, v25, v157
    v_fma_f32 v143, v127, v25, -v156
    v_fma_f32 v153, -v127, v25, v157
    v_fma_f32 v144, v128, v25, -v156
    v_fma_f32 v154, -v128, v25, v157
    v_fma_f32 v145, v129, v25, -v156
    v_fma_f32 v155, -v129, v25, v157
    v_exp_f32 v136, v136
    v_exp_f32 v137, v137
    v_exp_f32 v138, v138
    v_exp_f32 v139, v139
    v_exp_f32 v140, v140
    v_exp_f32 v141, v141
    v_exp_f32 v142, v142
    v_exp_f32 v143, v143
    v_exp_f32 v144, v144
    v_exp_f32 v145, v145
    v_exp_f32 v146, v146
    v_exp_f32 v147, v147
    v_exp_f32 v148, v148
    v_exp_f32 v149, v149
    v_exp_f32 v150, v150
    v_exp_f32 v151, v151
    v_exp_f32 v152, v152
    v_exp_f32 v153, v153
    v_exp_f32 v154, v154
    v_exp_f32 v155, v155
    v_add_f32 v160, v136, v137
    v_add_f32 v161, v146, v147
    v_add_f32 v160, v160, v138
    v_add_f32 v161, v161, v148
    v_add_f32 v160, v160, v139
    v_add_f32 v161, v161, v149
    v_add_f32 v160, v160, v140
    v_add_f32 v161, v161, v150
    v_add_f32 v160, v160, v141
    v_add_f32 v161, v161, v151
    v_add_f32 v160, v160, v142
    v_add_f32 v161, v161, v152
    v_add_f32 v160, v160, v143
    v_add_f32 v161, v161, v153
    v_add_f32 v160, v160, v144
    v_add_f32 v161, v161, v154
    v_add_f32 v160, v160, v145
    v_add_f32 v161, v161, v155
    v_mov_b32 v158, v160
    v_mov_b32 v159, v161
    s_nop 0
    v_permlane32_swap_b32 v160, v158
    v_permlane32_swap_b32 v161, v159
    v_add_f32 v160, v160, v158
    v_add_f32 v161, v161, v159
    v_rcp_f32 v160, v160
    v_rcp_f32 v161, v161
    v_mul_f32 v136, v136, v160
    v_mul_f32 v146, v146, v161
    v_mul_f32 v137, v137, v160
    v_mul_f32 v147, v147, v161
    v_mul_f32 v138, v138, v160
    v_mul_f32 v148, v148, v161
    v_mul_f32 v139, v139, v160
    v_mul_f32 v149, v149, v161
    v_mul_f32 v140, v140, v160
    v_mul_f32 v150, v150, v161
    v_mul_f32 v141, v141, v160
    v_mul_f32 v151, v151, v161
    v_mul_f32 v142, v142, v160
    v_mul_f32 v152, v152, v161
    v_mul_f32 v143, v143, v160
    v_mul_f32 v153, v153, v161
    v_mul_f32 v144, v144, v160
    v_mul_f32 v154, v154, v161
    v_mul_f32 v145, v145, v160
    v_mul_f32 v155, v155, v161
    v_cvt_pk_bf16_f32 v88, v136, v137
    v_cvt_pk_bf16_f32 v89, v138, v139
    v_cvt_pk_bf16_f32 v90, v140, v141
    v_cvt_pk_bf16_f32 v91, v142, v143
    v_cvt_pk_bf16_f32 v92, v144, v145
    v_cvt_pk_bf16_f32 v93, v146, v147
    v_cvt_pk_bf16_f32 v94, v148, v149
    v_cvt_pk_bf16_f32 v95, v150, v151
    v_cvt_pk_bf16_f32 v96, v152, v153
    v_cvt_pk_bf16_f32 v97, v154, v155
    s_waitcnt lgkmcnt(0)
    v_mfma_f32_32x32x16_bf16 v[120:135], v[48:51], v[78:81], 0
    v_mfma_f32_32x32x16_bf16 v[120:135], v[52:55], v[82:85], v[120:135]
    ds_write_b64 v170, v[88:89] offset:80
    ds_write_b64 v170, v[90:91] offset:88
    ds_write_b64 v170, v[92:93] offset:96
    ds_write_b64 v170, v[94:95] offset:104
    ds_write_b64 v170, v[96:97] offset:112
    v_max3_f32 v156, v104, v105, v106
    v_min3_f32 v157, v104, v105, v106
    v_max3_f32 v156, v156, v107, v108
    v_min3_f32 v157, v157, v107, v108
    v_max3_f32 v156, v156, v109, v110
    v_min3_f32 v157, v157, v109, v110
    v_max3_f32 v156, v156, v111, v112
    v_min3_f32 v157, v157, v111, v112
    v_max_f32 v156, v156, v113
    v_min_f32 v157, v157, v113
    v_mov_b32 v158, v156
    v_mov_b32 v159, v157
    s_nop 0
    v_permlane32_swap_b32 v156, v158
    v_permlane32_swap_b32 v157, v159
    v_max_f32 v156, v156, v158
    v_min_f32 v157, v157, v159
    v_mul_f32 v156, v156, v25
    v_mul_f32 v157, v157, v25
    v_fma_f32 v136, v104, v25, -v156
    v_fma_f32 v146, -v104, v25, v157
    v_fma_f32 v137, v105, v25, -v156
    v_fma_f32 v147, -v105, v25, v157
    v_fma_f32 v138, v106, v25, -v156
    v_fma_f32 v148, -v106, v25, v157
    v_fma_f32 v139, v107, v25, -v156
    v_fma_f32 v149, -v107, v25, v157
    v_fma_f32 v140, v108, v25, -v156
    v_fma_f32 v150, -v108, v25, v157
    v_fma_f32 v141, v109, v25, -v156
    v_fma_f32 v151, -v109, v25, v157
    v_fma_f32 v142, v110, v25, -v156
    v_fma_f32 v152, -v110, v25, v157
    v_fma_f32 v143, v111, v25, -v156
    v_fma_f32 v153, -v111, v25, v157
    v_fma_f32 v144, v112, v25, -v156
    v_fma_f32 v154, -v112, v25, v157
    v_fma_f32 v145, v113, v25, -v156
    v_fma_f32 v155, -v113, v25, v157
    v_exp_f32 v136, v136
    v_exp_f32 v137, v137
    v_exp_f32 v138, v138
    v_exp_f32 v139, v139
    v_exp_f32 v140, v140
    v_exp_f32 v141, v141
    v_exp_f32 v142, v142
    v_exp_f32 v143, v143
    v_exp_f32 v144, v144
    v_exp_f32 v145, v145
    v_exp_f32 v146, v146
    v_exp_f32 v147, v147
    v_exp_f32 v148, v148
    v_exp_f32 v149, v149
    v_exp_f32 v150, v150
    v_exp_f32 v151, v151
    v_exp_f32 v152, v152
    v_exp_f32 v153, v153
    v_exp_f32 v154, v154
    v_exp_f32 v155, v155
    v_add_f32 v160, v136, v137
    v_add_f32 v161, v146, v147
    v_add_f32 v160, v160, v138
    v_add_f32 v161, v161, v148
    v_add_f32 v160, v160, v139
    v_add_f32 v161, v161, v149
    v_add_f32 v160, v160, v140
    v_add_f32 v161, v161, v150
    v_add_f32 v160, v160, v141
    v_add_f32 v161, v161, v151
    v_add_f32 v160, v160, v142
    v_add_f32 v161, v161, v152
    v_add_f32 v160, v160, v143
    v_add_f32 v161, v161, v153
    v_add_f32 v160, v160, v144
    v_add_f32 v161, v161, v154
    v_add_f32 v160, v160, v145
    v_add_f32 v161, v161, v155
    v_mov_b32 v158, v160
    v_mov_b32 v159, v161
    s_nop 0
    v_permlane32_swap_b32 v160, v158
    v_permlane32_swap_b32 v161, v159
    v_add_f32 v160, v160, v158
    v_add_f32 v161, v161, v159
    v_rcp_f32 v160, v160
    v_rcp_f32 v161, v161
    v_mul_f32 v136, v136, v160
    v_mul_f32 v146, v146, v161
    v_mul_f32 v137, v137, v160
    v_mul_f32 v147, v147, v161
    v_mul_f32 v138, v138, v160
    v_mul_f32 v148, v148, v161
    v_mul_f32 v139, v139, v160
    v_mul_f32 v149, v149, v161
    v_mul_f32 v140, v140, v160
    v_mul_f32 v150, v150, v161
    v_mul_f32 v141, v141, v160
    v_mul_f32 v151, v151, v161
    v_mul_f32 v142, v142, v160
    v_mul_f32 v152, v152, v161
    v_mul_f32 v143, v143, v160
    v_mul_f32 v153, v153, v161
    v_mul_f32 v144, v144, v160
    v_mul_f32 v154, v154, v161
    v_mul_f32 v145, v145, v160
    v_mul_f32 v155, v155, v161
    v_cvt_pk_bf16_f32 v88, v136, v137
    v_cvt_pk_bf16_f32 v89, v138, v139
    v_cvt_pk_bf16_f32 v90, v140, v141
    v_cvt_pk_bf16_f32 v91, v142, v143
    v_cvt_pk_bf16_f32 v92, v144, v145
    v_cvt_pk_bf16_f32 v93, v146, v147
    v_cvt_pk_bf16_f32 v94, v148, v149
    v_cvt_pk_bf16_f32 v95, v150, v151
    v_cvt_pk_bf16_f32 v96, v152, v153
    v_cvt_pk_bf16_f32 v97, v154, v155
    ds_write_b64 v170, v[88:89] offset:160
    ds_write_b64 v170, v[90:91] offset:168
    ds_write_b64 v170, v[92:93] offset:176
    ds_write_b64 v170, v[94:95] offset:184
    ds_write_b64 v170, v[96:97] offset:192
    v_max3_f32 v156, v120, v121, v122
    v_min3_f32 v157, v120, v121, v122
    v_max3_f32 v156, v156, v123, v124
    v_min3_f32 v157, v157, v123, v124
    v_max3_f32 v156, v156, v125, v126
    v_min3_f32 v157, v157, v125, v126
    v_max3_f32 v156, v156, v127, v128
    v_min3_f32 v157, v157, v127, v128
    v_max_f32 v156, v156, v129
    v_min_f32 v157, v157, v129
    v_mov_b32 v158, v156
    v_mov_b32 v159, v157
    s_nop 0
    v_permlane32_swap_b32 v156, v158
    v_permlane32_swap_b32 v157, v159
    v_max_f32 v156, v156, v158
    v_min_f32 v157, v157, v159
    v_mul_f32 v156, v156, v25
    v_mul_f32 v157, v157, v25
    v_fma_f32 v136, v120, v25, -v156
    v_fma_f32 v146, -v120, v25, v157
    v_fma_f32 v137, v121, v25, -v156
    v_fma_f32 v147, -v121, v25, v157
    v_fma_f32 v138, v122, v25, -v156
    v_fma_f32 v148, -v122, v25, v157
    v_fma_f32 v139, v123, v25, -v156
    v_fma_f32 v149, -v123, v25, v157
    v_fma_f32 v140, v124, v25, -v156
    v_fma_f32 v150, -v124, v25, v157
    v_fma_f32 v141, v125, v25, -v156
    v_fma_f32 v151, -v125, v25, v157
    v_fma_f32 v142, v126, v25, -v156
    v_fma_f32 v152, -v126, v25, v157
    v_fma_f32 v143, v127, v25, -v156
    v_fma_f32 v153, -v127, v25, v157
    v_fma_f32 v144, v128, v25, -v156
    v_fma_f32 v154, -v128, v25, v157
    v_fma_f32 v145, v129, v25, -v156
    v_fma_f32 v155, -v129, v25, v157
    v_exp_f32 v136, v136
    v_exp_f32 v137, v137
    v_exp_f32 v138, v138
    v_exp_f32 v139, v139
    v_exp_f32 v140, v140
    v_exp_f32 v141, v141
    v_exp_f32 v142, v142
    v_exp_f32 v143, v143
    v_exp_f32 v144, v144
    v_exp_f32 v145, v145
    v_exp_f32 v146, v146
    v_exp_f32 v147, v147
    v_exp_f32 v148, v148
    v_exp_f32 v149, v149
    v_exp_f32 v150, v150
    v_exp_f32 v151, v151
    v_exp_f32 v152, v152
    v_exp_f32 v153, v153
    v_exp_f32 v154, v154
    v_exp_f32 v155, v155
    v_add_f32 v160, v136, v137
    v_add_f32 v161, v146, v147
    v_add_f32 v160, v160, v138
    v_add_f32 v161, v161, v148
    v_add_f32 v160, v160, v139
    v_add_f32 v161, v161, v149
    v_add_f32 v160, v160, v140
    v_add_f32 v161, v161, v150
    v_add_f32 v160, v160, v141
    v_add_f32 v161, v161, v151
    v_add_f32 v160, v160, v142
    v_add_f32 v161, v161, v152
    v_add_f32 v160, v160, v143
    v_add_f32 v161, v161, v153
    v_add_f32 v160, v160, v144
    v_add_f32 v161, v161, v154
    v_add_f32 v160, v160, v145
    v_add_f32 v161, v161, v155
    v_mov_b32 v158, v160
    v_mov_b32 v159, v161
    s_nop 0
    v_permlane32_swap_b32 v160, v158
    v_permlane32_swap_b32 v161, v159
    v_add_f32 v160, v160, v158
    v_add_f32 v161, v161, v159
    v_rcp_f32 v160, v160
    v_rcp_f32 v161, v161
    v_mul_f32 v136, v136, v160
    v_mul_f32 v146, v146, v161
    v_mul_f32 v137, v137, v160
    v_mul_f32 v147, v147, v161
    v_mul_f32 v138, v138, v160
    v_mul_f32 v148, v148, v161
    v_mul_f32 v139, v139, v160
    v_mul_f32 v149, v149, v161
    v_mul_f32 v140, v140, v160
    v_mul_f32 v150, v150, v161
    v_mul_f32 v141, v141, v160
    v_mul_f32 v151, v151, v161
    v_mul_f32 v142, v142, v160
    v_mul_f32 v152, v152, v161
    v_mul_f32 v143, v143, v160
    v_mul_f32 v153, v153, v161
    v_mul_f32 v144, v144, v160
    v_mul_f32 v154, v154, v161
    v_mul_f32 v145, v145, v160
    v_mul_f32 v155, v155, v161
    v_cvt_pk_bf16_f32 v88, v136, v137
    v_cvt_pk_bf16_f32 v89, v138, v139
    v_cvt_pk_bf16_f32 v90, v140, v141
    v_cvt_pk_bf16_f32 v91, v142, v143
    v_cvt_pk_bf16_f32 v92, v144, v145
    v_cvt_pk_bf16_f32 v93, v146, v147
    v_cvt_pk_bf16_f32 v94, v148, v149
    v_cvt_pk_bf16_f32 v95, v150, v151
    v_cvt_pk_bf16_f32 v96, v152, v153
    v_cvt_pk_bf16_f32 v97, v154, v155
    ds_write_b64 v170, v[88:89] offset:240
    ds_write_b64 v170, v[90:91] offset:248
    ds_write_b64 v170, v[92:93] offset:256
    ds_write_b64 v170, v[94:95] offset:264
    ds_write_b64 v170, v[96:97] offset:272
    s_waitcnt lgkmcnt(0)
    s_barrier
    ds_read_b64_tr_b16 v[64:65], v164
    v_add_u32 v164, v164, v165
    ds_read_b64_tr_b16 v[66:67], v164
    v_lshl_add_u32 v164, v165, 1, v164
    v_add_u32 v164, v164, v165
    ds_read_b64_tr_b16 v[68:69], v166 offset:0
    ds_read_b64_tr_b16 v[70:71], v166 offset:1280
    ds_read_b64_tr_b16 v[72:73], v164
    v_add_u32 v164, v164, v165
    ds_read_b64_tr_b16 v[74:75], v164
    v_lshl_add_u32 v164, v165, 1, v164
    v_add_u32 v164, v164, v165
    ds_read_b64_tr_b16 v[76:77], v166 offset:5120
    ds_read_b64_tr_b16 v[78:79], v166 offset:6400
    ds_read_b64_tr_b16 v[80:81], v164
    v_add_u32 v164, v164, v165
    ds_read_b64_tr_b16 v[82:83], v164
    v_lshl_add_u32 v164, v165, 1, v164
    v_add_u32 v164, v164, v165
    ds_read_b64_tr_b16 v[84:85], v166 offset:10240
    ds_read_b64_tr_b16 v[86:87], v166 offset:11520
    s_waitcnt lgkmcnt(8)
    v_mfma_f32_32x32x16_bf16 v[104:119], v[64:67], v[68:71], 0
    ds_read_b64_tr_b16 v[64:65], v164
    v_add_u32 v164, v164, v165
    ds_read_b64_tr_b16 v[66:67], v164
    v_lshl_add_u32 v164, v165, 1, v164
    v_add_u32 v164, v164, v165
    ds_read_b64_tr_b16 v[68:69], v166 offset:15360
    ds_read_b64_tr_b16 v[70:71], v166 offset:16640
    s_waitcnt lgkmcnt(8)
    v_mfma_f32_32x32x16_bf16 v[104:119], v[72:75], v[76:79], v[104:119]
    ds_read_b64_tr_b16 v[72:73], v164
    v_add_u32 v164, v164, v165
    ds_read_b64_tr_b16 v[74:75], v164
    v_lshl_add_u32 v164, v165, 1, v164
    v_add_u32 v164, v164, v165
    ds_read_b64_tr_b16 v[76:77], v166 offset:20480
    ds_read_b64_tr_b16 v[78:79], v166 offset:21760
    s_waitcnt lgkmcnt(8)
    v_mfma_f32_32x32x16_bf16 v[104:119], v[80:83], v[84:87], v[104:119]
    ds_read_b64_tr_b16 v[80:81], v164
    v_add_u32 v164, v164, v165
    ds_read_b64_tr_b16 v[82:83], v164
    v_lshl_add_u32 v164, v165, 1, v164
    v_add_u32 v164, v164, v165
    ds_read_b64_tr_b16 v[84:85], v166 offset:25600
    ds_read_b64_tr_b16 v[86:87], v166 offset:26880
    s_waitcnt lgkmcnt(8)
    v_mfma_f32_32x32x16_bf16 v[104:119], v[64:67], v[68:71], v[104:119]
    ds_read_b64_tr_b16 v[64:65], v164
    v_add_u32 v164, v164, v165
    ds_read_b64_tr_b16 v[66:67], v164
    v_lshl_add_u32 v164, v165, 1, v164
    v_add_u32 v164, v164, v165
    ds_read_b64_tr_b16 v[68:69], v166 offset:30720
    ds_read_b64_tr_b16 v[70:71], v166 offset:32000
    s_waitcnt lgkmcnt(8)
    v_mfma_f32_32x32x16_bf16 v[104:119], v[72:75], v[76:79], v[104:119]
    ds_read_b64_tr_b16 v[72:73], v164
    v_add_u32 v164, v164, v165
    ds_read_b64_tr_b16 v[74:75], v164
    v_lshl_add_u32 v164, v165, 1, v164
    v_add_u32 v164, v164, v165
    ds_read_b64_tr_b16 v[76:77], v166 offset:35840
    ds_read_b64_tr_b16 v[78:79], v166 offset:37120
    s_waitcnt lgkmcnt(8)
    v_mfma_f32_32x32x16_bf16 v[104:119], v[80:83], v[84:87], v[104:119]
    ds_read_b64_tr_b16 v[80:81], v164
    v_add_u32 v164, v164, v165
    ds_read_b64_tr_b16 v[82:83], v164
    v_lshl_add_u32 v164, v165, 1, v164
    v_add_u32 v164, v164, v165
    ds_read_b64_tr_b16 v[84:85], v167 offset:0
    ds_read_b64_tr_b16 v[86:87], v167 offset:1280
    s_waitcnt lgkmcnt(8)
    v_mfma_f32_32x32x16_bf16 v[104:119], v[64:67], v[68:71], v[104:119]
    ds_read_b64_tr_b16 v[64:65], v164
    v_add_u32 v164, v164, v165
    ds_read_b64_tr_b16 v[66:67], v164
    v_lshl_add_u32 v164, v165, 1, v164
    v_add_u32 v164, v164, v165
    ds_read_b64_tr_b16 v[68:69], v167 offset:5120
    ds_read_b64_tr_b16 v[70:71], v167 offset:6400
    s_waitcnt lgkmcnt(8)
    v_mfma_f32_32x32x16_bf16 v[104:119], v[72:75], v[76:79], v[104:119]
    ds_read_b64_tr_b16 v[72:73], v164
    v_add_u32 v164, v164, v165
    ds_read_b64_tr_b16 v[74:75], v164
    v_lshl_add_u32 v164, v165, 1, v164
    v_add_u32 v164, v164, v165
    ds_read_b64_tr_b16 v[76:77], v167 offset:10240
    ds_read_b64_tr_b16 v[78:79], v167 offset:11520
    s_waitcnt lgkmcnt(8)
    v_mfma_f32_32x32x16_bf16 v[104:119], v[80:83], v[84:87], v[104:119]
    ds_read_b64_tr_b16 v[80:81], v164
    v_add_u32 v164, v164, v165
    ds_read_b64_tr_b16 v[82:83], v164
    v_lshl_add_u32 v164, v165, 1, v164
    v_add_u32 v164, v164, v165
    ds_read_b64_tr_b16 v[84:85], v167 offset:15360
    ds_read_b64_tr_b16 v[86:87], v167 offset:16640
    s_waitcnt lgkmcnt(8)
    v_mfma_f32_32x32x16_bf16 v[104:119], v[64:67], v[68:71], v[104:119]
    ds_read_b64_tr_b16 v[64:65], v164
    v_add_u32 v164, v164, v165
    ds_read_b64_tr_b16 v[66:67], v164
    v_lshl_add_u32 v164, v165, 1, v164
    v_add_u32 v164, v164, v165
    ds_read_b64_tr_b16 v[68:69], v167 offset:20480
    ds_read_b64_tr_b16 v[70:71], v167 offset:21760
    s_waitcnt lgkmcnt(8)
    v_mfma_f32_32x32x16_bf16 v[104:119], v[72:75], v[76:79], v[104:119]
    ds_read_b64_tr_b16 v[72:73], v164
    v_add_u32 v164, v164, v165
    ds_read_b64_tr_b16 v[74:75], v164
    v_lshl_add_u32 v164, v165, 1, v164
    v_add_u32 v164, v164, v165
    ds_read_b64_tr_b16 v[76:77], v167 offset:25600
    ds_read_b64_tr_b16 v[78:79], v167 offset:26880
    s_waitcnt lgkmcnt(8)
    v_mfma_f32_32x32x16_bf16 v[104:119], v[80:83], v[84:87], v[104:119]
    ds_read_b64_tr_b16 v[80:81], v164
    v_add_u32 v164, v164, v165
    ds_read_b64_tr_b16 v[82:83], v164
    v_lshl_add_u32 v164, v165, 1, v164
    v_add_u32 v164, v164, v165
    ds_read_b64_tr_b16 v[84:85], v167 offset:30720
    ds_read_b64_tr_b16 v[86:87], v167 offset:32000
    s_waitcnt lgkmcnt(8)
    v_mfma_f32_32x32x16_bf16 v[104:119], v[64:67], v[68:71], v[104:119]
    ds_read_b64_tr_b16 v[64:65], v164
    v_add_u32 v164, v164, v165
    ds_read_b64_tr_b16 v[66:67], v164
    v_lshl_add_u32 v164, v165, 1, v164
    v_add_u32 v164, v164, v165
    ds_read_b64_tr_b16 v[68:69], v167 offset:35840
    ds_read_b64_tr_b16 v[70:71], v167 offset:37120
    s_waitcnt lgkmcnt(8)
    v_mfma_f32_32x32x16_bf16 v[104:119], v[72:75], v[76:79], v[104:119]
    s_waitcnt lgkmcnt(4)
    v_mfma_f32_32x32x16_bf16 v[104:119], v[80:83], v[84:87], v[104:119]
    s_waitcnt lgkmcnt(0)
    v_mfma_f32_32x32x16_bf16 v[104:119], v[64:67], v[68:71], v[104:119]
    s_nop 11
    buffer_atomic_add_f32 v104, v168, s[36:39], s66 offen offset:0
    buffer_atomic_add_f32 v105, v168, s[36:39], s66 offen offset:160
    buffer_atomic_add_f32 v106, v168, s[36:39], s66 offen offset:320
    buffer_atomic_add_f32 v107, v168, s[36:39], s66 offen offset:480
    buffer_atomic_add_f32 v108, v168, s[36:39], s66 offen offset:1280
    buffer_atomic_add_f32 v109, v168, s[36:39], s66 offen offset:1440
    buffer_atomic_add_f32 v110, v168, s[36:39], s66 offen offset:1600
    buffer_atomic_add_f32 v111, v168, s[36:39], s66 offen offset:1760
    buffer_atomic_add_f32 v112, v168, s[36:39], s66 offen offset:2560
    buffer_atomic_add_f32 v113, v169, s[36:39], s66 offen offset:2720
    buffer_atomic_add_f32 v114, v169, s[36:39], s66 offen offset:2880
    buffer_atomic_add_f32 v115, v169, s[36:39], s66 offen offset:3040
    s_waitcnt vmcnt(0)
    s_barrier
    s_lshl_b32 s78, s55, 8
    s_add_u32 s78, s78, 9064448
    s_cmp_eq_u32 s52, 0
    s_cbranch_scc0 L_arr_11
    v_mov_b32 v2, 1
    v_mov_b32 v3, 1073741824
    v_cmp_eq_u32 vcc, 0, v1
    s_nop 1
    v_cndmask_b32 v3, v3, v1, vcc
    buffer_atomic_add v2, v3, s[36:39], s78 offen
L_arr_11:
    s_branch L_end
L_q:
    v_mul_f32 v25, 0x3fb8aa3b, v24
    v_mov_b32 v38, v173
    v_mov_b32 v39, v174
    v_mov_b32 v30, v172
    ds_read_b128 v[40:43], v30 offset:0
    ds_read_b128 v[44:47], v30 offset:1024
    ds_read_b128 v[48:51], v30 offset:2048
    ds_read_b128 v[52:55], v30 offset:3072
    v_cvt_pk_bf16_f32 v60, v176, v177
    v_cvt_pk_bf16_f32 v61, v178, v179
    v_cvt_pk_bf16_f32 v62, v180, v181
    v_cvt_pk_bf16_f32 v63, v182, v183
    v_cvt_pk_bf16_f32 v64, v192, v193
    v_cvt_pk_bf16_f32 v65, v194, v195
    v_cvt_pk_bf16_f32 v66, v196, v197
    v_cvt_pk_bf16_f32 v67, v198, v199
    v_cvt_pk_bf16_f32 v68, v208, v209
    v_cvt_pk_bf16_f32 v69, v210, v211
    v_cvt_pk_bf16_f32 v70, v212, v213
    v_cvt_pk_bf16_f32 v71, v214, v215
    v_cvt_pk_bf16_f32 v72, v224, v225
    v_cvt_pk_bf16_f32 v73, v226, v227
    v_cvt_pk_bf16_f32 v74, v228, v229
    v_cvt_pk_bf16_f32 v75, v230, v231
    v_cvt_pk_bf16_f32 v76, v240, v241
    v_cvt_pk_bf16_f32 v77, v242, v243
    v_cvt_pk_bf16_f32 v78, v244, v245
    v_cvt_pk_bf16_f32 v79, v246, v247
    v_mov_b32 v80, 0
    v_mov_b32 v81, 0
    v_cvt_pk_bf16_f32 v82, v184, v185
    v_cvt_pk_bf16_f32 v83, v186, v187
    v_cvt_pk_bf16_f32 v84, v188, v189
    v_cvt_pk_bf16_f32 v85, v190, v191
    v_cvt_pk_bf16_f32 v86, v200, v201
    v_cvt_pk_bf16_f32 v87, v202, v203
    v_cvt_pk_bf16_f32 v88, v204, v205
    v_cvt_pk_bf16_f32 v89, v206, v207
    v_cvt_pk_bf16_f32 v90, v216, v217
    v_cvt_pk_bf16_f32 v91, v218, v219
    v_cvt_pk_bf16_f32 v92, v220, v221
    v_cvt_pk_bf16_f32 v93, v222, v223
    v_cvt_pk_bf16_f32 v94, v232, v233
    v_cvt_pk_bf16_f32 v95, v234, v235
    v_cvt_pk_bf16_f32 v96, v236, v237
    v_cvt_pk_bf16_f32 v97, v238, v239
    v_cvt_pk_bf16_f32 v98, v248, v249
    v_cvt_pk_bf16_f32 v99, v250, v251
    v_cvt_pk_bf16_f32 v100, v252, v253
    v_cvt_pk_bf16_f32 v101, v254, v255
    v_mov_b32 v102, 0
    v_mov_b32 v103, 0
    s_waitcnt lgkmcnt(0)
    v_mfma_f32_32x32x16_bf16 v[104:119], v[40:43], v[60:63], 0
    v_mfma_f32_32x32x16_bf16 v[104:119], v[44:47], v[64:67], v[104:119]
    v_mfma_f32_32x32x16_bf16 v[120:135], v[48:51], v[64:67], 0
    v_mfma_f32_32x32x16_bf16 v[120:135], v[52:55], v[68:71], v[120:135]
    ds_read_b128 v[40:43], v30 offset:4096
    ds_read_b128 v[44:47], v30 offset:5120
    s_nop 7
    v_max3_f32 v32, v104, v105, v106
    v_min3_f32 v33, v104, v105, v106
    v_max3_f32 v32, v32, v107, v108
    v_min3_f32 v33, v33, v107, v108
    v_max3_f32 v32, v32, v109, v110
    v_min3_f32 v33, v33, v109, v110
    v_max3_f32 v32, v32, v111, v112
    v_min3_f32 v33, v33, v111, v112
    v_max_f32 v32, v32, v113
    v_min_f32 v33, v33, v113
    v_mov_b32 v34, v32
    v_mov_b32 v35, v33
    s_nop 0
    v_permlane32_swap_b32 v32, v34
    v_permlane32_swap_b32 v33, v35
    v_max_f32 v32, v32, v34
    v_min_f32 v33, v33, v35
    v_mul_f32 v32, v32, v25
    v_mul_f32 v33, v33, v25
    v_fma_f32 v136, v104, v25, -v32
    v_fma_f32 v146, -v104, v25, v33
    v_fma_f32 v137, v105, v25, -v32
    v_fma_f32 v147, -v105, v25, v33
    v_fma_f32 v138, v106, v25, -v32
    v_fma_f32 v148, -v106, v25, v33
    v_fma_f32 v139, v107, v25, -v32
    v_fma_f32 v149, -v107, v25, v33
    v_fma_f32 v140, v108, v25, -v32
    v_fma_f32 v150, -v108, v25, v33
    v_fma_f32 v141, v109, v25, -v32
    v_fma_f32 v151, -v109, v25, v33
    v_fma_f32 v142, v110, v25, -v32
    v_fma_f32 v152, -v110, v25, v33
    v_fma_f32 v143, v111, v25, -v32
    v_fma_f32 v153, -v111, v25, v33
    v_fma_f32 v144, v112, v25, -v32
    v_fma_f32 v154, -v112, v25, v33
    v_fma_f32 v145, v113, v25, -v32
    v_fma_f32 v155, -v113, v25, v33
    v_exp_f32 v136, v136
    v_exp_f32 v137, v137
    v_exp_f32 v138, v138
    v_exp_f32 v139, v139
    v_exp_f32 v140, v140
    v_exp_f32 v141, v141
    v_exp_f32 v142, v142
    v_exp_f32 v143, v143
    v_exp_f32 v144, v144
    v_exp_f32 v145, v145
    v_exp_f32 v146, v146
    v_exp_f32 v147, v147
    v_exp_f32 v148, v148
    v_exp_f32 v149, v149
    v_exp_f32 v150, v150
    v_exp_f32 v151, v151
    v_exp_f32 v152, v152
    v_exp_f32 v153, v153
    v_exp_f32 v154, v154
    v_exp_f32 v155, v155
    v_add_f32 v36, v136, v137
    v_add_f32 v37, v146, v147
    v_add_f32 v36, v36, v138
    v_add_f32 v37, v37, v148
    v_add_f32 v36, v36, v139
    v_add_f32 v37, v37, v149
    v_add_f32 v36, v36, v140
    v_add_f32 v37, v37, v150
    v_add_f32 v36, v36, v141
    v_add_f32 v37, v37, v151
    v_add_f32 v36, v36, v142
    v_add_f32 v37, v37, v152
    v_add_f32 v36, v36, v143
    v_add_f32 v37, v37, v153
    v_add_f32 v36, v36, v144
    v_add_f32 v37, v37, v154
    v_add_f32 v36, v36, v145
    v_add_f32 v37, v37, v155
    v_mov_b32 v34, v36
    v_mov_b32 v35, v37
    s_nop 0
    v_permlane32_swap_b32 v36, v34
    v_permlane32_swap_b32 v37, v35
    v_add_f32 v36, v36, v34
    v_add_f32 v37, v37, v35
    v_rcp_f32 v36, v36
    v_rcp_f32 v37, v37
    v_mul_f32 v136, v136, v36
    v_mul_f32 v146, v146, v37
    v_mul_f32 v137, v137, v36
    v_mul_f32 v147, v147, v37
    v_mul_f32 v138, v138, v36
    v_mul_f32 v148, v148, v37
    v_mul_f32 v139, v139, v36
    v_mul_f32 v149, v149, v37
    v_mul_f32 v140, v140, v36
    v_mul_f32 v150, v150, v37
    v_mul_f32 v141, v141, v36
    v_mul_f32 v151, v151, v37
    v_mul_f32 v142, v142, v36
    v_mul_f32 v152, v152, v37
    v_mul_f32 v143, v143, v36
    v_mul_f32 v153, v153, v37
    v_mul_f32 v144, v144, v36
    v_mul_f32 v154, v154, v37
    v_mul_f32 v145, v145, v36
    v_mul_f32 v155, v155, v37
    v_cvt_pk_bf16_f32 v160, v136, v137
    v_cvt_pk_bf16_f32 v161, v138, v139
    v_cvt_pk_bf16_f32 v162, v140, v141
    v_cvt_pk_bf16_f32 v163, v142, v143
    v_cvt_pk_bf16_f32 v164, v144, v145
    v_cvt_pk_bf16_f32 v165, v146, v147
    v_cvt_pk_bf16_f32 v166, v148, v149
    v_cvt_pk_bf16_f32 v167, v150, v151
    v_cvt_pk_bf16_f32 v168, v152, v153
    v_cvt_pk_bf16_f32 v169, v154, v155
    v_mov_b32 v170, 0
    v_mov_b32 v171, 0
    s_waitcnt lgkmcnt(0)
    v_mfma_f32_32x32x16_bf16 v[104:119], v[40:43], v[70:73], 0
    v_mfma_f32_32x32x16_bf16 v[104:119], v[44:47], v[74:77], v[104:119]
    ds_read_b128 v[48:51], v30 offset:6144
    ds_read_b128 v[52:55], v30 offset:7168
    v_max3_f32 v32, v120, v121, v122
    v_min3_f32 v33, v120, v121, v122
    v_max3_f32 v32, v32, v123, v124
    v_min3_f32 v33, v33, v123, v124
    v_max3_f32 v32, v32, v125, v126
    v_min3_f32 v33, v33, v125, v126
    v_max3_f32 v32, v32, v127, v128
    v_min3_f32 v33, v33, v127, v128
    v_max_f32 v32, v32, v129
    v_min_f32 v33, v33, v129
    v_mov_b32 v34, v32
    v_mov_b32 v35, v33
    s_nop 0
    v_permlane32_swap_b32 v32, v34
    v_permlane32_swap_b32 v33, v35
    v_max_f32 v32, v32, v34
    v_min_f32 v33, v33, v35
    v_mul_f32 v32, v32, v25
    v_mul_f32 v33, v33, v25
    v_fma_f32 v136, v120, v25, -v32
    v_fma_f32 v146, -v120, v25, v33
    v_fma_f32 v137, v121, v25, -v32
    v_fma_f32 v147, -v121, v25, v33
    v_fma_f32 v138, v122, v25, -v32
    v_fma_f32 v148, -v122, v25, v33
    v_fma_f32 v139, v123, v25, -v32
    v_fma_f32 v149, -v123, v25, v33
    v_fma_f32 v140, v124, v25, -v32
    v_fma_f32 v150, -v124, v25, v33
    v_fma_f32 v141, v125, v25, -v32
    v_fma_f32 v151, -v125, v25, v33
    v_fma_f32 v142, v126, v25, -v32
    v_fma_f32 v152, -v126, v25, v33
    v_fma_f32 v143, v127, v25, -v32
    v_fma_f32 v153, -v127, v25, v33
    v_fma_f32 v144, v128, v25, -v32
    v_fma_f32 v154, -v128, v25, v33
    v_fma_f32 v145, v129, v25, -v32
    v_fma_f32 v155, -v129, v25, v33
    v_exp_f32 v136, v136
    v_exp_f32 v137, v137
    v_exp_f32 v138, v138
    v_exp_f32 v139, v139
    v_exp_f32 v140, v140
    v_exp_f32 v141, v141
    v_exp_f32 v142, v142
    v_exp_f32 v143, v143
    v_exp_f32 v144, v144
    v_exp_f32 v145, v145
    v_exp_f32 v146, v146
    v_exp_f32 v147, v147
    v_exp_f32 v148, v148
    v_exp_f32 v149, v149
    v_exp_f32 v150, v150
    v_exp_f32 v151, v151
    v_exp_f32 v152, v152
    v_exp_f32 v153, v153
    v_exp_f32 v154, v154
    v_exp_f32 v155, v155
    v_add_f32 v36, v136, v137
    v_add_f32 v37, v146, v147
    v_add_f32 v36, v36, v138
    v_add_f32 v37, v37, v148
    v_add_f32 v36, v36, v139
    v_add_f32 v37, v37, v149
    v_add_f32 v36, v36, v140
    v_add_f32 v37, v37, v150
    v_add_f32 v36, v36, v141
    v_add_f32 v37, v37, v151
    v_add_f32 v36, v36, v142
    v_add_f32 v37, v37, v152
    v_add_f32 v36, v36, v143
    v_add_f32 v37, v37, v153
    v_add_f32 v36, v36, v144
    v_add_f32 v37, v37, v154
    v_add_f32 v36, v36, v145
    v_add_f32 v37, v37, v155
    v_mov_b32 v34, v36
    v_mov_b32 v35, v37
    s_nop 0
    v_permlane32_swap_b32 v36, v34
    v_permlane32_swap_b32 v37, v35
    v_add_f32 v36, v36, v34
    v_add_f32 v37, v37, v35
    v_rcp_f32 v36, v36
    v_rcp_f32 v37, v37
    v_mul_f32 v136, v136, v36
    v_mul_f32 v146, v146, v37
    v_mul_f32 v137, v137, v36
    v_mul_f32 v147, v147, v37
    v_mul_f32 v138, v138, v36
    v_mul_f32 v148, v148, v37
    v_mul_f32 v139, v139, v36
    v_mul_f32 v149, v149, v37
    v_mul_f32 v140, v140, v36
    v_mul_f32 v150, v150, v37
    v_mul_f32 v141, v141, v36
    v_mul_f32 v151, v151, v37
    v_mul_f32 v142, v142, v36
    v_mul_f32 v152, v152, v37
    v_mul_f32 v143, v143, v36
    v_mul_f32 v153, v153, v37
    v_mul_f32 v144, v144, v36
    v_mul_f32 v154, v154, v37
    v_mul_f32 v145, v145, v36
    v_mul_f32 v155, v155, v37
    v_cvt_pk_bf16_f32 v172, v136, v137
    v_cvt_pk_bf16_f32 v173, v138, v139
    v_cvt_pk_bf16_f32 v174, v140, v141
    v_cvt_pk_bf16_f32 v175, v142, v143
    v_cvt_pk_bf16_f32 v176, v144, v145
    v_cvt_pk_bf16_f32 v177, v146, v147
    v_cvt_pk_bf16_f32 v178, v148, v149
    v_cvt_pk_bf16_f32 v179, v150, v151
    v_cvt_pk_bf16_f32 v180, v152, v153
    v_cvt_pk_bf16_f32 v181, v154, v155
    v_mov_b32 v182, 0
    v_mov_b32 v183, 0
    s_waitcnt lgkmcnt(0)
    v_mfma_f32_32x32x16_bf16 v[120:135], v[48:51], v[74:77], 0
    v_mfma_f32_32x32x16_bf16 v[120:135], v[52:55], v[78:81], v[120:135]
    ds_read_b128 v[40:43], v30 offset:8192
    ds_read_b128 v[44:47], v30 offset:9216
    v_max3_f32 v32, v104, v105, v106
    v_min3_f32 v33, v104, v105, v106
    v_max3_f32 v32, v32, v107, v108
    v_min3_f32 v33, v33, v107, v108
    v_max3_f32 v32, v32, v109, v110
    v_min3_f32 v33, v33, v109, v110
    v_max3_f32 v32, v32, v111, v112
    v_min3_f32 v33, v33, v111, v112
    v_max_f32 v32, v32, v113
    v_min_f32 v33, v33, v113
    v_mov_b32 v34, v32
    v_mov_b32 v35, v33
    s_nop 0
    v_permlane32_swap_b32 v32, v34
    v_permlane32_swap_b32 v33, v35
    v_max_f32 v32, v32, v34
    v_min_f32 v33, v33, v35
    v_mul_f32 v32, v32, v25
    v_mul_f32 v33, v33, v25
    v_fma_f32 v136, v104, v25, -v32
    v_fma_f32 v146, -v104, v25, v33
    v_fma_f32 v137, v105, v25, -v32
    v_fma_f32 v147, -v105, v25, v33
    v_fma_f32 v138, v106, v25, -v32
    v_fma_f32 v148, -v106, v25, v33
    v_fma_f32 v139, v107, v25, -v32
    v_fma_f32 v149, -v107, v25, v33
    v_fma_f32 v140, v108, v25, -v32
    v_fma_f32 v150, -v108, v25, v33
    v_fma_f32 v141, v109, v25, -v32
    v_fma_f32 v151, -v109, v25, v33
    v_fma_f32 v142, v110, v25, -v32
    v_fma_f32 v152, -v110, v25, v33
    v_fma_f32 v143, v111, v25, -v32
    v_fma_f32 v153, -v111, v25, v33
    v_fma_f32 v144, v112, v25, -v32
    v_fma_f32 v154, -v112, v25, v33
    v_fma_f32 v145, v113, v25, -v32
    v_fma_f32 v155, -v113, v25, v33
    v_exp_f32 v136, v136
    v_exp_f32 v137, v137
    v_exp_f32 v138, v138
    v_exp_f32 v139, v139
    v_exp_f32 v140, v140
    v_exp_f32 v141, v141
    v_exp_f32 v142, v142
    v_exp_f32 v143, v143
    v_exp_f32 v144, v144
    v_exp_f32 v145, v145
    v_exp_f32 v146, v146
    v_exp_f32 v147, v147
    v_exp_f32 v148, v148
    v_exp_f32 v149, v149
    v_exp_f32 v150, v150
    v_exp_f32 v151, v151
    v_exp_f32 v152, v152
    v_exp_f32 v153, v153
    v_exp_f32 v154, v154
    v_exp_f32 v155, v155
    v_add_f32 v36, v136, v137
    v_add_f32 v37, v146, v147
    v_add_f32 v36, v36, v138
    v_add_f32 v37, v37, v148
    v_add_f32 v36, v36, v139
    v_add_f32 v37, v37, v149
    v_add_f32 v36, v36, v140
    v_add_f32 v37, v37, v150
    v_add_f32 v36, v36, v141
    v_add_f32 v37, v37, v151
    v_add_f32 v36, v36, v142
    v_add_f32 v37, v37, v152
    v_add_f32 v36, v36, v143
    v_add_f32 v37, v37, v153
    v_add_f32 v36, v36, v144
    v_add_f32 v37, v37, v154
    v_add_f32 v36, v36, v145
    v_add_f32 v37, v37, v155
    v_mov_b32 v34, v36
    v_mov_b32 v35, v37
    s_nop 0
    v_permlane32_swap_b32 v36, v34
    v_permlane32_swap_b32 v37, v35
    v_add_f32 v36, v36, v34
    v_add_f32 v37, v37, v35
    v_rcp_f32 v36, v36
    v_rcp_f32 v37, v37
    v_mul_f32 v136, v136, v36
    v_mul_f32 v146, v146, v37
    v_mul_f32 v137, v137, v36
    v_mul_f32 v147, v147, v37
    v_mul_f32 v138, v138, v36
    v_mul_f32 v148, v148, v37
    v_mul_f32 v139, v139, v36
    v_mul_f32 v149, v149, v37
    v_mul_f32 v140, v140, v36
    v_mul_f32 v150, v150, v37
    v_mul_f32 v141, v141, v36
    v_mul_f32 v151, v151, v37
    v_mul_f32 v142, v142, v36
    v_mul_f32 v152, v152, v37
    v_mul_f32 v143, v143, v36
    v_mul_f32 v153, v153, v37
    v_mul_f32 v144, v144, v36
    v_mul_f32 v154, v154, v37
    v_mul_f32 v145, v145, v36
    v_mul_f32 v155, v155, v37
    v_cvt_pk_bf16_f32 v184, v136, v137
    v_cvt_pk_bf16_f32 v185, v138, v139
    v_cvt_pk_bf16_f32 v186, v140, v141
    v_cvt_pk_bf16_f32 v187, v142, v143
    v_cvt_pk_bf16_f32 v188, v144, v145
    v_cvt_pk_bf16_f32 v189, v146, v147
    v_cvt_pk_bf16_f32 v190, v148, v149
    v_cvt_pk_bf16_f32 v191, v150, v151
    v_cvt_pk_bf16_f32 v192, v152, v153
    v_cvt_pk_bf16_f32 v193, v154, v155
    v_mov_b32 v194, 0
    v_mov_b32 v195, 0
    s_waitcnt lgkmcnt(0)
    v_mfma_f32_32x32x16_bf16 v[104:119], v[40:43], v[82:85], 0
    v_mfma_f32_32x32x16_bf16 v[104:119], v[44:47], v[86:89], v[104:119]
    ds_read_b128 v[48:51], v30 offset:10240
    ds_read_b128 v[52:55], v30 offset:11264
    v_max3_f32 v32, v120, v121, v122
    v_min3_f32 v33, v120, v121, v122
    v_max3_f32 v32, v32, v123, v124
    v_min3_f32 v33, v33, v123, v124
    v_max3_f32 v32, v32, v125, v126
    v_min3_f32 v33, v33, v125, v126
    v_max3_f32 v32, v32, v127, v128
    v_min3_f32 v33, v33, v127, v128
    v_max_f32 v32, v32, v129
    v_min_f32 v33, v33, v129
    v_mov_b32 v34, v32
    v_mov_b32 v35, v33
    s_nop 0
    v_permlane32_swap_b32 v32, v34
    v_permlane32_swap_b32 v33, v35
    v_max_f32 v32, v32, v34
    v_min_f32 v33, v33, v35
    v_mul_f32 v32, v32, v25
    v_mul_f32 v33, v33, v25
    v_fma_f32 v136, v120, v25, -v32
    v_fma_f32 v146, -v120, v25, v33
    v_fma_f32 v137, v121, v25, -v32
    v_fma_f32 v147, -v121, v25, v33
    v_fma_f32 v138, v122, v25, -v32
    v_fma_f32 v148, -v122, v25, v33
    v_fma_f32 v139, v123, v25, -v32
    v_fma_f32 v149, -v123, v25, v33
    v_fma_f32 v140, v124, v25, -v32
    v_fma_f32 v150, -v124, v25, v33
    v_fma_f32 v141, v125, v25, -v32
    v_fma_f32 v151, -v125, v25, v33
    v_fma_f32 v142, v126, v25, -v32
    v_fma_f32 v152, -v126, v25, v33
    v_fma_f32 v143, v127, v25, -v32
    v_fma_f32 v153, -v127, v25, v33
    v_fma_f32 v144, v128, v25, -v32
    v_fma_f32 v154, -v128, v25, v33
    v_fma_f32 v145, v129, v25, -v32
    v_fma_f32 v155, -v129, v25, v33
    v_exp_f32 v136, v136
    v_exp_f32 v137, v137
    v_exp_f32 v138, v138
    v_exp_f32 v139, v139
    v_exp_f32 v140, v140
    v_exp_f32 v141, v141
    v_exp_f32 v142, v142
    v_exp_f32 v143, v143
    v_exp_f32 v144, v144
    v_exp_f32 v145, v145
    v_exp_f32 v146, v146
    v_exp_f32 v147, v147
    v_exp_f32 v148, v148
    v_exp_f32 v149, v149
    v_exp_f32 v150, v150
    v_exp_f32 v151, v151
    v_exp_f32 v152, v152
    v_exp_f32 v153, v153
    v_exp_f32 v154, v154
    v_exp_f32 v155, v155
    v_add_f32 v36, v136, v137
    v_add_f32 v37, v146, v147
    v_add_f32 v36, v36, v138
    v_add_f32 v37, v37, v148
    v_add_f32 v36, v36, v139
    v_add_f32 v37, v37, v149
    v_add_f32 v36, v36, v140
    v_add_f32 v37, v37, v150
    v_add_f32 v36, v36, v141
    v_add_f32 v37, v37, v151
    v_add_f32 v36, v36, v142
    v_add_f32 v37, v37, v152
    v_add_f32 v36, v36, v143
    v_add_f32 v37, v37, v153
    v_add_f32 v36, v36, v144
    v_add_f32 v37, v37, v154
    v_add_f32 v36, v36, v145
    v_add_f32 v37, v37, v155
    v_mov_b32 v34, v36
    v_mov_b32 v35, v37
    s_nop 0
    v_permlane32_swap_b32 v36, v34
    v_permlane32_swap_b32 v37, v35
    v_add_f32 v36, v36, v34
    v_add_f32 v37, v37, v35
    v_rcp_f32 v36, v36
    v_rcp_f32 v37, v37
    v_mul_f32 v136, v136, v36
    v_mul_f32 v146, v146, v37
    v_mul_f32 v137, v137, v36
    v_mul_f32 v147, v147, v37
    v_mul_f32 v138, v138, v36
    v_mul_f32 v148, v148, v37
    v_mul_f32 v139, v139, v36
    v_mul_f32 v149, v149, v37
    v_mul_f32 v140, v140, v36
    v_mul_f32 v150, v150, v37
    v_mul_f32 v141, v141, v36
    v_mul_f32 v151, v151, v37
    v_mul_f32 v142, v142, v36
    v_mul_f32 v152, v152, v37
    v_mul_f32 v143, v143, v36
    v_mul_f32 v153, v153, v37
    v_mul_f32 v144, v144, v36
    v_mul_f32 v154, v154, v37
    v_mul_f32 v145, v145, v36
    v_mul_f32 v155, v155, v37
    v_cvt_pk_bf16_f32 v196, v136, v137
    v_cvt_pk_bf16_f32 v197, v138, v139
    v_cvt_pk_bf16_f32 v198, v140, v141
    v_cvt_pk_bf16_f32 v199, v142, v143
    v_cvt_pk_bf16_f32 v200, v144, v145
    v_cvt_pk_bf16_f32 v201, v146, v147
    v_cvt_pk_bf16_f32 v202, v148, v149
    v_cvt_pk_bf16_f32 v203, v150, v151
    v_cvt_pk_bf16_f32 v204, v152, v153
    v_cvt_pk_bf16_f32 v205, v154, v155
    v_mov_b32 v206, 0
    v_mov_b32 v207, 0
    s_waitcnt lgkmcnt(0)
    v_mfma_f32_32x32x16_bf16 v[120:135], v[48:51], v[86:89], 0
    v_mfma_f32_32x32x16_bf16 v[120:135], v[52:55], v[90:93], v[120:135]
    ds_read_b128 v[40:43], v30 offset:12288
    ds_read_b128 v[44:47], v30 offset:13312
    v_max3_f32 v32, v104, v105, v106
    v_min3_f32 v33, v104, v105, v106
    v_max3_f32 v32, v32, v107, v108
    v_min3_f32 v33, v33, v107, v108
    v_max3_f32 v32, v32, v109, v110
    v_min3_f32 v33, v33, v109, v110
    v_max3_f32 v32, v32, v111, v112
    v_min3_f32 v33, v33, v111, v112
    v_max_f32 v32, v32, v113
    v_min_f32 v33, v33, v113
    v_mov_b32 v34, v32
    v_mov_b32 v35, v33
    s_nop 0
    v_permlane32_swap_b32 v32, v34
    v_permlane32_swap_b32 v33, v35
    v_max_f32 v32, v32, v34
    v_min_f32 v33, v33, v35
    v_mul_f32 v32, v32, v25
    v_mul_f32 v33, v33, v25
    v_fma_f32 v136, v104, v25, -v32
    v_fma_f32 v146, -v104, v25, v33
    v_fma_f32 v137, v105, v25, -v32
    v_fma_f32 v147, -v105, v25, v33
    v_fma_f32 v138, v106, v25, -v32
    v_fma_f32 v148, -v106, v25, v33
    v_fma_f32 v139, v107, v25, -v32
    v_fma_f32 v149, -v107, v25, v33
    v_fma_f32 v140, v108, v25, -v32
    v_fma_f32 v150, -v108, v25, v33
    v_fma_f32 v141, v109, v25, -v32
    v_fma_f32 v151, -v109, v25, v33
    v_fma_f32 v142, v110, v25, -v32
    v_fma_f32 v152, -v110, v25, v33
    v_fma_f32 v143, v111, v25, -v32
    v_fma_f32 v153, -v111, v25, v33
    v_fma_f32 v144, v112, v25, -v32
    v_fma_f32 v154, -v112, v25, v33
    v_fma_f32 v145, v113, v25, -v32
    v_fma_f32 v155, -v113, v25, v33
    v_exp_f32 v136, v136
    v_exp_f32 v137, v137
    v_exp_f32 v138, v138
    v_exp_f32 v139, v139
    v_exp_f32 v140, v140
    v_exp_f32 v141, v141
    v_exp_f32 v142, v142
    v_exp_f32 v143, v143
    v_exp_f32 v144, v144
    v_exp_f32 v145, v145
    v_exp_f32 v146, v146
    v_exp_f32 v147, v147
    v_exp_f32 v148, v148
    v_exp_f32 v149, v149
    v_exp_f32 v150, v150
    v_exp_f32 v151, v151
    v_exp_f32 v152, v152
    v_exp_f32 v153, v153
    v_exp_f32 v154, v154
    v_exp_f32 v155, v155
    v_add_f32 v36, v136, v137
    v_add_f32 v37, v146, v147
    v_add_f32 v36, v36, v138
    v_add_f32 v37, v37, v148
    v_add_f32 v36, v36, v139
    v_add_f32 v37, v37, v149
    v_add_f32 v36, v36, v140
    v_add_f32 v37, v37, v150
    v_add_f32 v36, v36, v141
    v_add_f32 v37, v37, v151
    v_add_f32 v36, v36, v142
    v_add_f32 v37, v37, v152
    v_add_f32 v36, v36, v143
    v_add_f32 v37, v37, v153
    v_add_f32 v36, v36, v144
    v_add_f32 v37, v37, v154
    v_add_f32 v36, v36, v145
    v_add_f32 v37, v37, v155
    v_mov_b32 v34, v36
    v_mov_b32 v35, v37
    s_nop 0
    v_permlane32_swap_b32 v36, v34
    v_permlane32_swap_b32 v37, v35
    v_add_f32 v36, v36, v34
    v_add_f32 v37, v37, v35
    v_rcp_f32 v36, v36
    v_rcp_f32 v37, v37
    v_mul_f32 v136, v136, v36
    v_mul_f32 v146, v146, v37
    v_mul_f32 v137, v137, v36
    v_mul_f32 v147, v147, v37
    v_mul_f32 v138, v138, v36
    v_mul_f32 v148, v148, v37
    v_mul_f32 v139, v139, v36
    v_mul_f32 v149, v149, v37
    v_mul_f32 v140, v140, v36
    v_mul_f32 v150, v150, v37
    v_mul_f32 v141, v141, v36
    v_mul_f32 v151, v151, v37
    v_mul_f32 v142, v142, v36
    v_mul_f32 v152, v152, v37
    v_mul_f32 v143, v143, v36
    v_mul_f32 v153, v153, v37
    v_mul_f32 v144, v144, v36
    v_mul_f32 v154, v154, v37
    v_mul_f32 v145, v145, v36
    v_mul_f32 v155, v155, v37
    v_cvt_pk_bf16_f32 v208, v136, v137
    v_cvt_pk_bf16_f32 v209, v138, v139
    v_cvt_pk_bf16_f32 v210, v140, v141
    v_cvt_pk_bf16_f32 v211, v142, v143
    v_cvt_pk_bf16_f32 v212, v144, v145
    v_cvt_pk_bf16_f32 v213, v146, v147
    v_cvt_pk_bf16_f32 v214, v148, v149
    v_cvt_pk_bf16_f32 v215, v150, v151
    v_cvt_pk_bf16_f32 v216, v152, v153
    v_cvt_pk_bf16_f32 v217, v154, v155
    v_mov_b32 v218, 0
    v_mov_b32 v219, 0
    s_waitcnt lgkmcnt(0)
    v_mfma_f32_32x32x16_bf16 v[104:119], v[40:43], v[92:95], 0
    v_mfma_f32_32x32x16_bf16 v[104:119], v[44:47], v[96:99], v[104:119]
    ds_read_b128 v[48:51], v30 offset:14336
    ds_read_b128 v[52:55], v30 offset:15360
    v_max3_f32 v32, v120, v121, v122
    v_min3_f32 v33, v120, v121, v122
    v_max3_f32 v32, v32, v123, v124
    v_min3_f32 v33, v33, v123, v124
    v_max3_f32 v32, v32, v125, v126
    v_min3_f32 v33, v33, v125, v126
    v_max3_f32 v32, v32, v127, v128
    v_min3_f32 v33, v33, v127, v128
    v_max_f32 v32, v32, v129
    v_min_f32 v33, v33, v129
    v_mov_b32 v34, v32
    v_mov_b32 v35, v33
    s_nop 0
    v_permlane32_swap_b32 v32, v34
    v_permlane32_swap_b32 v33, v35
    v_max_f32 v32, v32, v34
    v_min_f32 v33, v33, v35
    v_mul_f32 v32, v32, v25
    v_mul_f32 v33, v33, v25
    v_fma_f32 v136, v120, v25, -v32
    v_fma_f32 v146, -v120, v25, v33
    v_fma_f32 v137, v121, v25, -v32
    v_fma_f32 v147, -v121, v25, v33
    v_fma_f32 v138, v122, v25, -v32
    v_fma_f32 v148, -v122, v25, v33
    v_fma_f32 v139, v123, v25, -v32
    v_fma_f32 v149, -v123, v25, v33
    v_fma_f32 v140, v124, v25, -v32
    v_fma_f32 v150, -v124, v25, v33
    v_fma_f32 v141, v125, v25, -v32
    v_fma_f32 v151, -v125, v25, v33
    v_fma_f32 v142, v126, v25, -v32
    v_fma_f32 v152, -v126, v25, v33
    v_fma_f32 v143, v127, v25, -v32
    v_fma_f32 v153, -v127, v25, v33
    v_fma_f32 v144, v128, v25, -v32
    v_fma_f32 v154, -v128, v25, v33
    v_fma_f32 v145, v129, v25, -v32
    v_fma_f32 v155, -v129, v25, v33
    v_exp_f32 v136, v136
    v_exp_f32 v137, v137
    v_exp_f32 v138, v138
    v_exp_f32 v139, v139
    v_exp_f32 v140, v140
    v_exp_f32 v141, v141
    v_exp_f32 v142, v142
    v_exp_f32 v143, v143
    v_exp_f32 v144, v144
    v_exp_f32 v145, v145
    v_exp_f32 v146, v146
    v_exp_f32 v147, v147
    v_exp_f32 v148, v148
    v_exp_f32 v149, v149
    v_exp_f32 v150, v150
    v_exp_f32 v151, v151
    v_exp_f32 v152, v152
    v_exp_f32 v153, v153
    v_exp_f32 v154, v154
    v_exp_f32 v155, v155
    v_add_f32 v36, v136, v137
    v_add_f32 v37, v146, v147
    v_add_f32 v36, v36, v138
    v_add_f32 v37, v37, v148
    v_add_f32 v36, v36, v139
    v_add_f32 v37, v37, v149
    v_add_f32 v36, v36, v140
    v_add_f32 v37, v37, v150
    v_add_f32 v36, v36, v141
    v_add_f32 v37, v37, v151
    v_add_f32 v36, v36, v142
    v_add_f32 v37, v37, v152
    v_add_f32 v36, v36, v143
    v_add_f32 v37, v37, v153
    v_add_f32 v36, v36, v144
    v_add_f32 v37, v37, v154
    v_add_f32 v36, v36, v145
    v_add_f32 v37, v37, v155
    v_mov_b32 v34, v36
    v_mov_b32 v35, v37
    s_nop 0
    v_permlane32_swap_b32 v36, v34
    v_permlane32_swap_b32 v37, v35
    v_add_f32 v36, v36, v34
    v_add_f32 v37, v37, v35
    v_rcp_f32 v36, v36
    v_rcp_f32 v37, v37
    v_mul_f32 v136, v136, v36
    v_mul_f32 v146, v146, v37
    v_mul_f32 v137, v137, v36
    v_mul_f32 v147, v147, v37
    v_mul_f32 v138, v138, v36
    v_mul_f32 v148, v148, v37
    v_mul_f32 v139, v139, v36
    v_mul_f32 v149, v149, v37
    v_mul_f32 v140, v140, v36
    v_mul_f32 v150, v150, v37
    v_mul_f32 v141, v141, v36
    v_mul_f32 v151, v151, v37
    v_mul_f32 v142, v142, v36
    v_mul_f32 v152, v152, v37
    v_mul_f32 v143, v143, v36
    v_mul_f32 v153, v153, v37
    v_mul_f32 v144, v144, v36
    v_mul_f32 v154, v154, v37
    v_mul_f32 v145, v145, v36
    v_mul_f32 v155, v155, v37
    v_cvt_pk_bf16_f32 v220, v136, v137
    v_cvt_pk_bf16_f32 v221, v138, v139
    v_cvt_pk_bf16_f32 v222, v140, v141
    v_cvt_pk_bf16_f32 v223, v142, v143
    v_cvt_pk_bf16_f32 v224, v144, v145
    v_cvt_pk_bf16_f32 v225, v146, v147
    v_cvt_pk_bf16_f32 v226, v148, v149
    v_cvt_pk_bf16_f32 v227, v150, v151
    v_cvt_pk_bf16_f32 v228, v152, v153
    v_cvt_pk_bf16_f32 v229, v154, v155
    v_mov_b32 v230, 0
    v_mov_b32 v231, 0
    s_waitcnt lgkmcnt(0)
    v_mfma_f32_32x32x16_bf16 v[120:135], v[48:51], v[96:99], 0
    v_mfma_f32_32x32x16_bf16 v[120:135], v[52:55], v[100:103], v[120:135]
    v_max3_f32 v32, v104, v105, v106
    v_min3_f32 v33, v104, v105, v106
    v_max3_f32 v32, v32, v107, v108
    v_min3_f32 v33, v33, v107, v108
    v_max3_f32 v32, v32, v109, v110
    v_min3_f32 v33, v33, v109, v110
    v_max3_f32 v32, v32, v111, v112
    v_min3_f32 v33, v33, v111, v112
    v_max_f32 v32, v32, v113
    v_min_f32 v33, v33, v113
    v_mov_b32 v34, v32
    v_mov_b32 v35, v33
    s_nop 0
    v_permlane32_swap_b32 v32, v34
    v_permlane32_swap_b32 v33, v35
    v_max_f32 v32, v32, v34
    v_min_f32 v33, v33, v35
    v_mul_f32 v32, v32, v25
    v_mul_f32 v33, v33, v25
    v_fma_f32 v136, v104, v25, -v32
    v_fma_f32 v146, -v104, v25, v33
    v_fma_f32 v137, v105, v25, -v32
    v_fma_f32 v147, -v105, v25, v33
    v_fma_f32 v138, v106, v25, -v32
    v_fma_f32 v148, -v106, v25, v33
    v_fma_f32 v139, v107, v25, -v32
    v_fma_f32 v149, -v107, v25, v33
    v_fma_f32 v140, v108, v25, -v32
    v_fma_f32 v150, -v108, v25, v33
    v_fma_f32 v141, v109, v25, -v32
    v_fma_f32 v151, -v109, v25, v33
    v_fma_f32 v142, v110, v25, -v32
    v_fma_f32 v152, -v110, v25, v33
    v_fma_f32 v143, v111, v25, -v32
    v_fma_f32 v153, -v111, v25, v33
    v_fma_f32 v144, v112, v25, -v32
    v_fma_f32 v154, -v112, v25, v33
    v_fma_f32 v145, v113, v25, -v32
    v_fma_f32 v155, -v113, v25, v33
    v_exp_f32 v136, v136
    v_exp_f32 v137, v137
    v_exp_f32 v138, v138
    v_exp_f32 v139, v139
    v_exp_f32 v140, v140
    v_exp_f32 v141, v141
    v_exp_f32 v142, v142
    v_exp_f32 v143, v143
    v_exp_f32 v144, v144
    v_exp_f32 v145, v145
    v_exp_f32 v146, v146
    v_exp_f32 v147, v147
    v_exp_f32 v148, v148
    v_exp_f32 v149, v149
    v_exp_f32 v150, v150
    v_exp_f32 v151, v151
    v_exp_f32 v152, v152
    v_exp_f32 v153, v153
    v_exp_f32 v154, v154
    v_exp_f32 v155, v155
    v_add_f32 v36, v136, v137
    v_add_f32 v37, v146, v147
    v_add_f32 v36, v36, v138
    v_add_f32 v37, v37, v148
    v_add_f32 v36, v36, v139
    v_add_f32 v37, v37, v149
    v_add_f32 v36, v36, v140
    v_add_f32 v37, v37, v150
    v_add_f32 v36, v36, v141
    v_add_f32 v37, v37, v151
    v_add_f32 v36, v36, v142
    v_add_f32 v37, v37, v152
    v_add_f32 v36, v36, v143
    v_add_f32 v37, v37, v153
    v_add_f32 v36, v36, v144
    v_add_f32 v37, v37, v154
    v_add_f32 v36, v36, v145
    v_add_f32 v37, v37, v155
    v_mov_b32 v34, v36
    v_mov_b32 v35, v37
    s_nop 0
    v_permlane32_swap_b32 v36, v34
    v_permlane32_swap_b32 v37, v35
    v_add_f32 v36, v36, v34
    v_add_f32 v37, v37, v35
    v_rcp_f32 v36, v36
    v_rcp_f32 v37, v37
    v_mul_f32 v136, v136, v36
    v_mul_f32 v146, v146, v37
    v_mul_f32 v137, v137, v36
    v_mul_f32 v147, v147, v37
    v_mul_f32 v138, v138, v36
    v_mul_f32 v148, v148, v37
    v_mul_f32 v139, v139, v36
    v_mul_f32 v149, v149, v37
    v_mul_f32 v140, v140, v36
    v_mul_f32 v150, v150, v37
    v_mul_f32 v141, v141, v36
    v_mul_f32 v151, v151, v37
    v_mul_f32 v142, v142, v36
    v_mul_f32 v152, v152, v37
    v_mul_f32 v143, v143, v36
    v_mul_f32 v153, v153, v37
    v_mul_f32 v144, v144, v36
    v_mul_f32 v154, v154, v37
    v_mul_f32 v145, v145, v36
    v_mul_f32 v155, v155, v37
    v_cvt_pk_bf16_f32 v232, v136, v137
    v_cvt_pk_bf16_f32 v233, v138, v139
    v_cvt_pk_bf16_f32 v234, v140, v141
    v_cvt_pk_bf16_f32 v235, v142, v143
    v_cvt_pk_bf16_f32 v236, v144, v145
    v_cvt_pk_bf16_f32 v237, v146, v147
    v_cvt_pk_bf16_f32 v238, v148, v149
    v_cvt_pk_bf16_f32 v239, v150, v151
    v_cvt_pk_bf16_f32 v240, v152, v153
    v_cvt_pk_bf16_f32 v241, v154, v155
    v_mov_b32 v242, 0
    v_mov_b32 v243, 0
    v_max3_f32 v32, v120, v121, v122
    v_min3_f32 v33, v120, v121, v122
    v_max3_f32 v32, v32, v123, v124
    v_min3_f32 v33, v33, v123, v124
    v_max3_f32 v32, v32, v125, v126
    v_min3_f32 v33, v33, v125, v126
    v_max3_f32 v32, v32, v127, v128
    v_min3_f32 v33, v33, v127, v128
    v_max_f32 v32, v32, v129
    v_min_f32 v33, v33, v129
    v_mov_b32 v34, v32
    v_mov_b32 v35, v33
    s_nop 0
    v_permlane32_swap_b32 v32, v34
    v_permlane32_swap_b32 v33, v35
    v_max_f32 v32, v32, v34
    v_min_f32 v33, v33, v35
    v_mul_f32 v32, v32, v25
    v_mul_f32 v33, v33, v25
    v_fma_f32 v136, v120, v25, -v32
    v_fma_f32 v146, -v120, v25, v33
    v_fma_f32 v137, v121, v25, -v32
    v_fma_f32 v147, -v121, v25, v33
    v_fma_f32 v138, v122, v25, -v32
    v_fma_f32 v148, -v122, v25, v33
    v_fma_f32 v139, v123, v25, -v32
    v_fma_f32 v149, -v123, v25, v33
    v_fma_f32 v140, v124, v25, -v32
    v_fma_f32 v150, -v124, v25, v33
    v_fma_f32 v141, v125, v25, -v32
    v_fma_f32 v151, -v125, v25, v33
    v_fma_f32 v142, v126, v25, -v32
    v_fma_f32 v152, -v126, v25, v33
    v_fma_f32 v143, v127, v25, -v32
    v_fma_f32 v153, -v127, v25, v33
    v_fma_f32 v144, v128, v25, -v32
    v_fma_f32 v154, -v128, v25, v33
    v_fma_f32 v145, v129, v25, -v32
    v_fma_f32 v155, -v129, v25, v33
    v_exp_f32 v136, v136
    v_exp_f32 v137, v137
    v_exp_f32 v138, v138
    v_exp_f32 v139, v139
    v_exp_f32 v140, v140
    v_exp_f32 v141, v141
    v_exp_f32 v142, v142
    v_exp_f32 v143, v143
    v_exp_f32 v144, v144
    v_exp_f32 v145, v145
    v_exp_f32 v146, v146
    v_exp_f32 v147, v147
    v_exp_f32 v148, v148
    v_exp_f32 v149, v149
    v_exp_f32 v150, v150
    v_exp_f32 v151, v151
    v_exp_f32 v152, v152
    v_exp_f32 v153, v153
    v_exp_f32 v154, v154
    v_exp_f32 v155, v155
    v_add_f32 v36, v136, v137
    v_add_f32 v37, v146, v147
    v_add_f32 v36, v36, v138
    v_add_f32 v37, v37, v148
    v_add_f32 v36, v36, v139
    v_add_f32 v37, v37, v149
    v_add_f32 v36, v36, v140
    v_add_f32 v37, v37, v150
    v_add_f32 v36, v36, v141
    v_add_f32 v37, v37, v151
    v_add_f32 v36, v36, v142
    v_add_f32 v37, v37, v152
    v_add_f32 v36, v36, v143
    v_add_f32 v37, v37, v153
    v_add_f32 v36, v36, v144
    v_add_f32 v37, v37, v154
    v_add_f32 v36, v36, v145
    v_add_f32 v37, v37, v155
    v_mov_b32 v34, v36
    v_mov_b32 v35, v37
    s_nop 0
    v_permlane32_swap_b32 v36, v34
    v_permlane32_swap_b32 v37, v35
    v_add_f32 v36, v36, v34
    v_add_f32 v37, v37, v35
    v_rcp_f32 v36, v36
    v_rcp_f32 v37, v37
    v_mul_f32 v136, v136, v36
    v_mul_f32 v146, v146, v37
    v_mul_f32 v137, v137, v36
    v_mul_f32 v147, v147, v37
    v_mul_f32 v138, v138, v36
    v_mul_f32 v148, v148, v37
    v_mul_f32 v139, v139, v36
    v_mul_f32 v149, v149, v37
    v_mul_f32 v140, v140, v36
    v_mul_f32 v150, v150, v37
    v_mul_f32 v141, v141, v36
    v_mul_f32 v151, v151, v37
    v_mul_f32 v142, v142, v36
    v_mul_f32 v152, v152, v37
    v_mul_f32 v143, v143, v36
    v_mul_f32 v153, v153, v37
    v_mul_f32 v144, v144, v36
    v_mul_f32 v154, v154, v37
    v_mul_f32 v145, v145, v36
    v_mul_f32 v155, v155, v37
    v_cvt_pk_bf16_f32 v244, v136, v137
    v_cvt_pk_bf16_f32 v245, v138, v139
    v_cvt_pk_bf16_f32 v246, v140, v141
    v_cvt_pk_bf16_f32 v247, v142, v143
    v_cvt_pk_bf16_f32 v248, v144, v145
    v_cvt_pk_bf16_f32 v249, v146, v147
    v_cvt_pk_bf16_f32 v250, v148, v149
    v_cvt_pk_bf16_f32 v251, v150, v151
    v_cvt_pk_bf16_f32 v252, v152, v153
    v_cvt_pk_bf16_f32 v253, v154, v155
    v_mov_b32 v254, 0
    v_mov_b32 v255, 0
    s_cmp_eq_u32 s52, 0
    s_cbranch_scc0 L_q_nopoll
    s_lshl_b32 s78, s55, 9
    s_add_u32 s78, s78, 9064448
    s_add_u32 s79, s78, 256
    s_mov_b32 s80, 0
    v_mov_b32 v3, 0
    buffer_load_dword v4, v3, s[36:39], s78 offen sc1
    buffer_load_dword v5, v3, s[36:39], s79 offen sc1
    s_sleep 3
    buffer_load_dword v6, v3, s[36:39], s78 offen sc1
    buffer_load_dword v7, v3, s[36:39], s79 offen sc1
    s_sleep 3
    buffer_load_dword v8, v3, s[36:39], s78 offen sc1
    buffer_load_dword v9, v3, s[36:39], s79 offen sc1
L_poll_12:
    s_waitcnt vmcnt(4)
    v_min_u32 v2, v4, v5
    s_nop 0
    v_readfirstlane_b32 s81, v2
    s_nop 3
    s_cmp_ge_u32 s81, 8
    s_cbranch_scc1 L_polld_13
    buffer_load_dword v4, v3, s[36:39], s78 offen sc1
    buffer_load_dword v5, v3, s[36:39], s79 offen sc1
    s_waitcnt vmcnt(4)
    v_min_u32 v2, v6, v7
    s_nop 0
    v_readfirstlane_b32 s81, v2
    s_nop 3
    s_cmp_ge_u32 s81, 8
    s_cbranch_scc1 L_polld_13
    buffer_load_dword v6, v3, s[36:39], s78 offen sc1
    buffer_load_dword v7, v3, s[36:39], s79 offen sc1
    s_waitcnt vmcnt(4)
    v_min_u32 v2, v8, v9
    s_nop 0
    v_readfirstlane_b32 s81, v2
    s_nop 3
    s_cmp_ge_u32 s81, 8
    s_cbranch_scc1 L_polld_13
    buffer_load_dword v8, v3, s[36:39], s78 offen sc1
    buffer_load_dword v9, v3, s[36:39], s79 offen sc1
    s_add_u32 s80, s80, 1
    s_cmp_le_u32 s80, 100000
    s_cbranch_scc1 L_poll_12
L_polld_13:
    s_waitcnt vmcnt(0)
L_q_nopoll:
    s_barrier
    s_lshl_b32 s80, s55, 3
    s_add_u32 s80, s80, s52
    s_lshl_b32 s80, s80, 12
    s_add_u32 s80, s80, 8912896
    buffer_load_dwordx4 v[104:107], v38, s[36:39], s80 offen offset:0 sc1
    buffer_load_dwordx4 v[108:111], v38, s[36:39], s80 offen offset:16 sc1
    buffer_load_dwordx4 v[112:115], v38, s[36:39], s80 offen offset:32 sc1
    buffer_load_dwordx4 v[116:119], v38, s[36:39], s80 offen offset:48 sc1
    buffer_load_dwordx4 v[120:123], v38, s[36:39], s80 offen offset:64 sc1
    buffer_load_dwordx4 v[124:127], v38, s[36:39], s80 offen offset:80 sc1
    s_mul_i32 s81, s52, 3072
    v_add_u32 v5, s81, v39
    s_waitcnt vmcnt(4)
    v_cvt_pk_bf16_f32 v136, v104, v105
    v_cvt_pk_bf16_f32 v137, v106, v107
    v_cvt_pk_bf16_f32 v138, v108, v109
    v_cvt_pk_bf16_f32 v139, v110, v111
    ds_write_b128 v5, v[136:139] offset:0
    s_waitcnt vmcnt(2)
    v_cvt_pk_bf16_f32 v140, v112, v113
    v_cvt_pk_bf16_f32 v141, v114, v115
    v_cvt_pk_bf16_f32 v142, v116, v117
    v_cvt_pk_bf16_f32 v143, v118, v119
    ds_write_b128 v5, v[140:143] offset:1024
    s_waitcnt vmcnt(0)
    v_cvt_pk_bf16_f32 v144, v120, v121
    v_cvt_pk_bf16_f32 v145, v122, v123
    v_cvt_pk_bf16_f32 v146, v124, v125
    v_cvt_pk_bf16_f32 v147, v126, v127
    ds_write_b128 v5, v[144:147] offset:2048
    s_waitcnt lgkmcnt(0)
    s_barrier
    s_lshl_b32 s78, s53, 3
    s_add_u32 s78, s78, s52
    s_mul_i32 s78, s78, 136
    s_mul_i32 s79, s55, 10
    s_add_u32 s78, s78, s79
    s_add_u32 s78, s78, 96
    s_lshl_b32 s78, s78, 10
    ds_read_b128 v[104:107], v39 offset:0
    ds_read_b128 v[108:111], v39 offset:1024
    ds_read_b128 v[112:115], v39 offset:2048
    ds_read_b128 v[116:119], v39 offset:3072
    ds_read_b128 v[120:123], v39 offset:4096
    ds_read_b128 v[124:127], v39 offset:5120
    s_waitcnt lgkmcnt(3)
    v_mfma_f32_32x32x16_bf16 v[128:143], v[104:107], v[160:163], 0
    v_mfma_f32_32x32x16_bf16 v[128:143], v[108:111], v[164:167], v[128:143]
    v_mfma_f32_32x32x16_bf16 v[128:143], v[112:115], v[168:171], v[128:143]
    ds_read_b128 v[104:107], v39 offset:6144
    ds_read_b128 v[108:111], v39 offset:7168
    ds_read_b128 v[112:115], v39 offset:8192
    s_waitcnt lgkmcnt(3)
    v_mfma_f32_32x32x16_bf16 v[144:159], v[116:119], v[172:175], 0
    v_mfma_f32_32x32x16_bf16 v[144:159], v[120:123], v[176:179], v[144:159]
    v_mfma_f32_32x32x16_bf16 v[144:159], v[124:127], v[180:183], v[144:159]
    s_nop 4
    v_add_f32 v37, 0x358637bd, v138
    v_rcp_f32 v37, v37
    s_nop 0
    v_mul_f32 v128, v128, v37
    v_mul_f32 v129, v129, v37
    v_mul_f32 v130, v130, v37
    v_mul_f32 v131, v131, v37
    v_mul_f32 v132, v132, v37
    v_mul_f32 v133, v133, v37
    v_mul_f32 v134, v134, v37
    v_mul_f32 v135, v135, v37
    v_mul_f32 v136, v136, v37
    v_mul_f32 v137, v137, v37
    v_cvt_pk_bf16_f32 v60, v128, v129
    v_cvt_pk_bf16_f32 v61, v130, v131
    v_cvt_pk_bf16_f32 v62, v132, v133
    v_cvt_pk_bf16_f32 v63, v134, v135
    v_cvt_pk_bf16_f32 v64, v136, v137
    buffer_store_dwordx4 v[60:63], v39, s[36:39], s78 offen offset:0 sc1
    ds_read_b128 v[116:119], v39 offset:9216
    ds_read_b128 v[120:123], v39 offset:10240
    ds_read_b128 v[124:127], v39 offset:11264
    s_waitcnt lgkmcnt(3)
    v_mfma_f32_32x32x16_bf16 v[128:143], v[104:107], v[184:187], 0
    v_mfma_f32_32x32x16_bf16 v[128:143], v[108:111], v[188:191], v[128:143]
    v_mfma_f32_32x32x16_bf16 v[128:143], v[112:115], v[192:195], v[128:143]
    v_add_f32 v37, 0x358637bd, v154
    v_rcp_f32 v37, v37
    s_nop 0
    v_mul_f32 v144, v144, v37
    v_mul_f32 v145, v145, v37
    v_mul_f32 v146, v146, v37
    v_mul_f32 v147, v147, v37
    v_mul_f32 v148, v148, v37
    v_mul_f32 v149, v149, v37
    v_mul_f32 v150, v150, v37
    v_mul_f32 v151, v151, v37
    v_mul_f32 v152, v152, v37
    v_mul_f32 v153, v153, v37
    v_cvt_pk_bf16_f32 v65, v144, v145
    v_cvt_pk_bf16_f32 v66, v146, v147
    v_cvt_pk_bf16_f32 v67, v148, v149
    v_cvt_pk_bf16_f32 v68, v150, v151
    v_cvt_pk_bf16_f32 v69, v152, v153
    buffer_store_dwordx4 v[64:67], v39, s[36:39], s78 offen offset:1024 sc1
    ds_read_b128 v[104:107], v39 offset:12288
    ds_read_b128 v[108:111], v39 offset:13312
    ds_read_b128 v[112:115], v39 offset:14336
    s_waitcnt lgkmcnt(3)
    v_mfma_f32_32x32x16_bf16 v[144:159], v[116:119], v[196:199], 0
    v_mfma_f32_32x32x16_bf16 v[144:159], v[120:123], v[200:203], v[144:159]
    v_mfma_f32_32x32x16_bf16 v[144:159], v[124:127], v[204:207], v[144:159]
    v_add_f32 v37, 0x358637bd, v138
    v_rcp_f32 v37, v37
    s_nop 0
    v_mul_f32 v128, v128, v37
    v_mul_f32 v129, v129, v37
    v_mul_f32 v130, v130, v37
    v_mul_f32 v131, v131, v37
    v_mul_f32 v132, v132, v37
    v_mul_f32 v133, v133, v37
    v_mul_f32 v134, v134, v37
    v_mul_f32 v135, v135, v37
    v_mul_f32 v136, v136, v37
    v_mul_f32 v137, v137, v37
    v_cvt_pk_bf16_f32 v70, v128, v129
    v_cvt_pk_bf16_f32 v71, v130, v131
    v_cvt_pk_bf16_f32 v72, v132, v133
    v_cvt_pk_bf16_f32 v73, v134, v135
    v_cvt_pk_bf16_f32 v74, v136, v137
    buffer_store_dwordx4 v[68:71], v39, s[36:39], s78 offen offset:2048 sc1
    ds_read_b128 v[116:119], v39 offset:15360
    ds_read_b128 v[120:123], v39 offset:16384
    ds_read_b128 v[124:127], v39 offset:17408
    s_waitcnt lgkmcnt(3)
    v_mfma_f32_32x32x16_bf16 v[128:143], v[104:107], v[208:211], 0
    v_mfma_f32_32x32x16_bf16 v[128:143], v[108:111], v[212:215], v[128:143]
    v_mfma_f32_32x32x16_bf16 v[128:143], v[112:115], v[216:219], v[128:143]
    v_add_f32 v37, 0x358637bd, v154
    v_rcp_f32 v37, v37
    s_nop 0
    v_mul_f32 v144, v144, v37
    v_mul_f32 v145, v145, v37
    v_mul_f32 v146, v146, v37
    v_mul_f32 v147, v147, v37
    v_mul_f32 v148, v148, v37
    v_mul_f32 v149, v149, v37
    v_mul_f32 v150, v150, v37
    v_mul_f32 v151, v151, v37
    v_mul_f32 v152, v152, v37
    v_mul_f32 v153, v153, v37
    v_cvt_pk_bf16_f32 v75, v144, v145
    v_cvt_pk_bf16_f32 v76, v146, v147
    v_cvt_pk_bf16_f32 v77, v148, v149
    v_cvt_pk_bf16_f32 v78, v150, v151
    v_cvt_pk_bf16_f32 v79, v152, v153
    buffer_store_dwordx4 v[72:75], v39, s[36:39], s78 offen offset:3072 sc1
    s_add_u32 s78, s78, 4096
    buffer_store_dwordx4 v[76:79], v39, s[36:39], s78 offen offset:0 sc1
    ds_read_b128 v[104:107], v39 offset:18432
    ds_read_b128 v[108:111], v39 offset:19456
    ds_read_b128 v[112:115], v39 offset:20480
    s_waitcnt lgkmcnt(3)
    v_mfma_f32_32x32x16_bf16 v[144:159], v[116:119], v[220:223], 0
    v_mfma_f32_32x32x16_bf16 v[144:159], v[120:123], v[224:227], v[144:159]
    v_mfma_f32_32x32x16_bf16 v[144:159], v[124:127], v[228:231], v[144:159]
    v_add_f32 v37, 0x358637bd, v138
    v_rcp_f32 v37, v37
    s_nop 0
    v_mul_f32 v128, v128, v37
    v_mul_f32 v129, v129, v37
    v_mul_f32 v130, v130, v37
    v_mul_f32 v131, v131, v37
    v_mul_f32 v132, v132, v37
    v_mul_f32 v133, v133, v37
    v_mul_f32 v134, v134, v37
    v_mul_f32 v135, v135, v37
    v_mul_f32 v136, v136, v37
    v_mul_f32 v137, v137, v37
    v_cvt_pk_bf16_f32 v80, v128, v129
    v_cvt_pk_bf16_f32 v81, v130, v131
    v_cvt_pk_bf16_f32 v82, v132, v133
    v_cvt_pk_bf16_f32 v83, v134, v135
    v_cvt_pk_bf16_f32 v84, v136, v137
    buffer_store_dwordx4 v[80:83], v39, s[36:39], s78 offen offset:1024 sc1
    ds_read_b128 v[116:119], v39 offset:21504
    ds_read_b128 v[120:123], v39 offset:22528
    ds_read_b128 v[124:127], v39 offset:23552
    s_waitcnt lgkmcnt(3)
    v_mfma_f32_32x32x16_bf16 v[128:143], v[104:107], v[232:235], 0
    v_mfma_f32_32x32x16_bf16 v[128:143], v[108:111], v[236:239], v[128:143]
    v_mfma_f32_32x32x16_bf16 v[128:143], v[112:115], v[240:243], v[128:143]
    v_add_f32 v37, 0x358637bd, v154
    v_rcp_f32 v37, v37
    s_nop 0
    v_mul_f32 v144, v144, v37
    v_mul_f32 v145, v145, v37
    v_mul_f32 v146, v146, v37
    v_mul_f32 v147, v147, v37
    v_mul_f32 v148, v148, v37
    v_mul_f32 v149, v149, v37
    v_mul_f32 v150, v150, v37
    v_mul_f32 v151, v151, v37
    v_mul_f32 v152, v152, v37
    v_mul_f32 v153, v153, v37
    v_cvt_pk_bf16_f32 v85, v144, v145
    v_cvt_pk_bf16_f32 v86, v146, v147
    v_cvt_pk_bf16_f32 v87, v148, v149
    v_cvt_pk_bf16_f32 v88, v150, v151
    v_cvt_pk_bf16_f32 v89, v152, v153
    buffer_store_dwordx4 v[84:87], v39, s[36:39], s78 offen offset:2048 sc1
    s_waitcnt lgkmcnt(0)
    v_mfma_f32_32x32x16_bf16 v[144:159], v[116:119], v[244:247], 0
    v_mfma_f32_32x32x16_bf16 v[144:159], v[120:123], v[248:251], v[144:159]
    v_mfma_f32_32x32x16_bf16 v[144:159], v[124:127], v[252:255], v[144:159]
    v_add_f32 v37, 0x358637bd, v138
    v_rcp_f32 v37, v37
    s_nop 0
    v_mul_f32 v128, v128, v37
    v_mul_f32 v129, v129, v37
    v_mul_f32 v130, v130, v37
    v_mul_f32 v131, v131, v37
    v_mul_f32 v132, v132, v37
    v_mul_f32 v133, v133, v37
    v_mul_f32 v134, v134, v37
    v_mul_f32 v135, v135, v37
    v_mul_f32 v136, v136, v37
    v_mul_f32 v137, v137, v37
    v_cvt_pk_bf16_f32 v90, v128, v129
    v_cvt_pk_bf16_f32 v91, v130, v131
    v_cvt_pk_bf16_f32 v92, v132, v133
    v_cvt_pk_bf16_f32 v93, v134, v135
    v_cvt_pk_bf16_f32 v94, v136, v137
    buffer_store_dwordx4 v[88:91], v39, s[36:39], s78 offen offset:3072 sc1
    v_add_f32 v37, 0x358637bd, v154
    v_rcp_f32 v37, v37
    s_nop 0
    v_mul_f32 v144, v144, v37
    v_mul_f32 v145, v145, v37
    v_mul_f32 v146, v146, v37
    v_mul_f32 v147, v147, v37
    v_mul_f32 v148, v148, v37
    v_mul_f32 v149, v149, v37
    v_mul_f32 v150, v150, v37
    v_mul_f32 v151, v151, v37
    v_mul_f32 v152, v152, v37
    v_mul_f32 v153, v153, v37
    v_cvt_pk_bf16_f32 v95, v144, v145
    v_cvt_pk_bf16_f32 v96, v146, v147
    v_cvt_pk_bf16_f32 v97, v148, v149
    v_cvt_pk_bf16_f32 v98, v150, v151
    v_cvt_pk_bf16_f32 v99, v152, v153
    s_add_u32 s78, s78, 4096
    buffer_store_dwordx4 v[92:95], v39, s[36:39], s78 offen offset:0 sc1
    buffer_store_dwordx4 v[96:99], v39, s[36:39], s78 offen offset:1024 sc1
    s_waitcnt vmcnt(0)
    s_barrier
    s_lshl_b32 s78, s53, 8
    s_add_u32 s78, s78, 9062400
    s_cmp_eq_u32 s52, 0
    s_cbranch_scc0 L_arr_14
    v_mov_b32 v2, 1
    v_mov_b32 v3, 1073741824
    v_cmp_eq_u32 vcc, 0, v1
    s_nop 1
    v_cndmask_b32 v3, v3, v1, vcc
    buffer_atomic_add v2, v3, s[36:39], s78 offen
L_arr_14:
    s_branch L_end
L_ffn:
    s_barrier
    v_mul_f32 v25, 0xbfb8aa3b, v24
    v_lshlrev_b32 v26, 4, v1
    s_mov_b32 s44, s18
    s_mov_b32 s45, s19
    s_mov_b32 s46, 1966080
    s_mov_b32 s47, 0x00020000
    s_mov_b32 s48, s10
    s_mov_b32 s49, s11
    s_mov_b32 s50, 819200
    s_mov_b32 s51, 0x00020000
    s_mul_i32 s94, s52, 204800
    s_mul_i32 s96, s52, 20480
    s_lshl_b32 s60, s89, 7
    s_add_u32 s94, s94, s60
    s_lshl_b32 s78, s53, 3
    s_add_u32 s78, s78, s52
    s_mul_i32 s78, s78, 136
    s_add_u32 s78, s78, s95
    s_lshl_b32 s78, s78, 10
    s_cmp_eq_u32 s93, 0
    s_cselect_b32 s94, s82, s94
    v_mul_f32 v64, v176, v25
    v_mul_f32 v65, v177, v25
    v_mul_f32 v66, v178, v25
    v_mul_f32 v67, v179, v25
    v_mul_f32 v68, v180, v25
    v_mul_f32 v69, v181, v25
    v_mul_f32 v70, v182, v25
    v_mul_f32 v71, v183, v25
    v_exp_f32 v64, v64
    v_exp_f32 v65, v65
    v_exp_f32 v66, v66
    v_exp_f32 v67, v67
    v_exp_f32 v68, v68
    v_exp_f32 v69, v69
    v_exp_f32 v70, v70
    v_exp_f32 v71, v71
    s_add_u32 m0, s96, 0
    s_add_u32 s60, s94, 0
    buffer_load_dwordx4 v100, s[44:47], s60 offen lds
    v_mul_f32 v176, v176, v184
    v_mul_f32 v177, v177, v185
    v_mul_f32 v178, v178, v186
    v_mul_f32 v179, v179, v187
    v_mul_f32 v180, v180, v188
    v_mul_f32 v181, v181, v189
    v_mul_f32 v182, v182, v190
    v_mul_f32 v183, v183, v191
    v_fma_f32 v64, v64, v23, v23
    v_fma_f32 v65, v65, v23, v23
    v_fma_f32 v66, v66, v23, v23
    v_fma_f32 v67, v67, v23, v23
    v_fma_f32 v68, v68, v23, v23
    v_fma_f32 v69, v69, v23, v23
    v_fma_f32 v70, v70, v23, v23
    v_fma_f32 v71, v71, v23, v23
    v_rcp_f32 v64, v64
    v_rcp_f32 v65, v65
    v_rcp_f32 v66, v66
    v_rcp_f32 v67, v67
    v_rcp_f32 v68, v68
    v_rcp_f32 v69, v69
    v_rcp_f32 v70, v70
    v_rcp_f32 v71, v71
    s_add_u32 m0, s96, 1024
    s_add_u32 s60, s94, 0
    buffer_load_dwordx4 v101, s[44:47], s60 offen lds
    v_mul_f32 v176, v176, v64
    v_mul_f32 v177, v177, v65
    v_mul_f32 v178, v178, v66
    v_mul_f32 v179, v179, v67
    v_mul_f32 v180, v180, v68
    v_mul_f32 v181, v181, v69
    v_mul_f32 v182, v182, v70
    v_mul_f32 v183, v183, v71
    v_cvt_pk_bf16_f32 v72, v176, v177
    v_cvt_pk_bf16_f32 v73, v178, v179
    v_cvt_pk_bf16_f32 v74, v180, v181
    v_cvt_pk_bf16_f32 v75, v182, v183
    buffer_store_dwordx4 v[72:75], v26, s[36:39], s78 offen offset:0 sc1
    v_mul_f32 v76, v192, v25
    v_mul_f32 v77, v193, v25
    v_mul_f32 v78, v194, v25
    v_mul_f32 v79, v195, v25
    v_mul_f32 v80, v196, v25
    v_mul_f32 v81, v197, v25
    v_mul_f32 v82, v198, v25
    v_mul_f32 v83, v199, v25
    v_exp_f32 v76, v76
    v_exp_f32 v77, v77
    v_exp_f32 v78, v78
    v_exp_f32 v79, v79
    v_exp_f32 v80, v80
    v_exp_f32 v81, v81
    v_exp_f32 v82, v82
    v_exp_f32 v83, v83
    s_add_u32 m0, s96, 2048
    s_add_u32 s60, s94, 20480
    buffer_load_dwordx4 v100, s[44:47], s60 offen lds
    v_mul_f32 v192, v192, v200
    v_mul_f32 v193, v193, v201
    v_mul_f32 v194, v194, v202
    v_mul_f32 v195, v195, v203
    v_mul_f32 v196, v196, v204
    v_mul_f32 v197, v197, v205
    v_mul_f32 v198, v198, v206
    v_mul_f32 v199, v199, v207
    v_fma_f32 v76, v76, v23, v23
    v_fma_f32 v77, v77, v23, v23
    v_fma_f32 v78, v78, v23, v23
    v_fma_f32 v79, v79, v23, v23
    v_fma_f32 v80, v80, v23, v23
    v_fma_f32 v81, v81, v23, v23
    v_fma_f32 v82, v82, v23, v23
    v_fma_f32 v83, v83, v23, v23
    v_rcp_f32 v76, v76
    v_rcp_f32 v77, v77
    v_rcp_f32 v78, v78
    v_rcp_f32 v79, v79
    v_rcp_f32 v80, v80
    v_rcp_f32 v81, v81
    v_rcp_f32 v82, v82
    v_rcp_f32 v83, v83
    s_add_u32 m0, s96, 3072
    s_add_u32 s60, s94, 20480
    buffer_load_dwordx4 v101, s[44:47], s60 offen lds
    v_mul_f32 v192, v192, v76
    v_mul_f32 v193, v193, v77
    v_mul_f32 v194, v194, v78
    v_mul_f32 v195, v195, v79
    v_mul_f32 v196, v196, v80
    v_mul_f32 v197, v197, v81
    v_mul_f32 v198, v198, v82
    v_mul_f32 v199, v199, v83
    v_cvt_pk_bf16_f32 v84, v192, v193
    v_cvt_pk_bf16_f32 v85, v194, v195
    v_cvt_pk_bf16_f32 v86, v196, v197
    v_cvt_pk_bf16_f32 v87, v198, v199
    buffer_store_dwordx4 v[84:87], v26, s[36:39], s78 offen offset:1024 sc1
    v_mul_f32 v64, v208, v25
    v_mul_f32 v65, v209, v25
    v_mul_f32 v66, v210, v25
    v_mul_f32 v67, v211, v25
    v_mul_f32 v68, v212, v25
    v_mul_f32 v69, v213, v25
    v_mul_f32 v70, v214, v25
    v_mul_f32 v71, v215, v25
    v_exp_f32 v64, v64
    v_exp_f32 v65, v65
    v_exp_f32 v66, v66
    v_exp_f32 v67, v67
    v_exp_f32 v68, v68
    v_exp_f32 v69, v69
    v_exp_f32 v70, v70
    v_exp_f32 v71, v71
    s_add_u32 m0, s96, 4096
    s_add_u32 s60, s94, 40960
    buffer_load_dwordx4 v100, s[44:47], s60 offen lds
    v_mul_f32 v208, v208, v216
    v_mul_f32 v209, v209, v217
    v_mul_f32 v210, v210, v218
    v_mul_f32 v211, v211, v219
    v_mul_f32 v212, v212, v220
    v_mul_f32 v213, v213, v221
    v_mul_f32 v214, v214, v222
    v_mul_f32 v215, v215, v223
    v_fma_f32 v64, v64, v23, v23
    v_fma_f32 v65, v65, v23, v23
    v_fma_f32 v66, v66, v23, v23
    v_fma_f32 v67, v67, v23, v23
    v_fma_f32 v68, v68, v23, v23
    v_fma_f32 v69, v69, v23, v23
    v_fma_f32 v70, v70, v23, v23
    v_fma_f32 v71, v71, v23, v23
    v_rcp_f32 v64, v64
    v_rcp_f32 v65, v65
    v_rcp_f32 v66, v66
    v_rcp_f32 v67, v67
    v_rcp_f32 v68, v68
    v_rcp_f32 v69, v69
    v_rcp_f32 v70, v70
    v_rcp_f32 v71, v71
    s_add_u32 m0, s96, 5120
    s_add_u32 s60, s94, 40960
    buffer_load_dwordx4 v101, s[44:47], s60 offen lds
    v_mul_f32 v208, v208, v64
    v_mul_f32 v209, v209, v65
    v_mul_f32 v210, v210, v66
    v_mul_f32 v211, v211, v67
    v_mul_f32 v212, v212, v68
    v_mul_f32 v213, v213, v69
    v_mul_f32 v214, v214, v70
    v_mul_f32 v215, v215, v71
    v_cvt_pk_bf16_f32 v72, v208, v209
    v_cvt_pk_bf16_f32 v73, v210, v211
    v_cvt_pk_bf16_f32 v74, v212, v213
    v_cvt_pk_bf16_f32 v75, v214, v215
    buffer_store_dwordx4 v[72:75], v26, s[36:39], s78 offen offset:2048 sc1
    v_mul_f32 v76, v224, v25
    v_mul_f32 v77, v225, v25
    v_mul_f32 v78, v226, v25
    v_mul_f32 v79, v227, v25
    v_mul_f32 v80, v228, v25
    v_mul_f32 v81, v229, v25
    v_mul_f32 v82, v230, v25
    v_mul_f32 v83, v231, v25
    v_exp_f32 v76, v76
    v_exp_f32 v77, v77
    v_exp_f32 v78, v78
    v_exp_f32 v79, v79
    v_exp_f32 v80, v80
    v_exp_f32 v81, v81
    v_exp_f32 v82, v82
    v_exp_f32 v83, v83
    s_add_u32 m0, s96, 6144
    s_add_u32 s60, s94, 61440
    buffer_load_dwordx4 v100, s[44:47], s60 offen lds
    v_mul_f32 v224, v224, v232
    v_mul_f32 v225, v225, v233
    v_mul_f32 v226, v226, v234
    v_mul_f32 v227, v227, v235
    v_mul_f32 v228, v228, v236
    v_mul_f32 v229, v229, v237
    v_mul_f32 v230, v230, v238
    v_mul_f32 v231, v231, v239
    v_fma_f32 v76, v76, v23, v23
    v_fma_f32 v77, v77, v23, v23
    v_fma_f32 v78, v78, v23, v23
    v_fma_f32 v79, v79, v23, v23
    v_fma_f32 v80, v80, v23, v23
    v_fma_f32 v81, v81, v23, v23
    v_fma_f32 v82, v82, v23, v23
    v_fma_f32 v83, v83, v23, v23
    v_rcp_f32 v76, v76
    v_rcp_f32 v77, v77
    v_rcp_f32 v78, v78
    v_rcp_f32 v79, v79
    v_rcp_f32 v80, v80
    v_rcp_f32 v81, v81
    v_rcp_f32 v82, v82
    v_rcp_f32 v83, v83
    s_add_u32 m0, s96, 7168
    s_add_u32 s60, s94, 61440
    buffer_load_dwordx4 v101, s[44:47], s60 offen lds
    v_mul_f32 v224, v224, v76
    v_mul_f32 v225, v225, v77
    v_mul_f32 v226, v226, v78
    v_mul_f32 v227, v227, v79
    v_mul_f32 v228, v228, v80
    v_mul_f32 v229, v229, v81
    v_mul_f32 v230, v230, v82
    v_mul_f32 v231, v231, v83
    v_cvt_pk_bf16_f32 v84, v224, v225
    v_cvt_pk_bf16_f32 v85, v226, v227
    v_cvt_pk_bf16_f32 v86, v228, v229
    v_cvt_pk_bf16_f32 v87, v230, v231
    buffer_store_dwordx4 v[84:87], v26, s[36:39], s78 offen offset:3072 sc1
    v_mul_f32 v64, v240, v25
    v_mul_f32 v65, v241, v25
    v_mul_f32 v66, v242, v25
    v_mul_f32 v67, v243, v25
    v_mul_f32 v68, v244, v25
    v_mul_f32 v69, v245, v25
    v_mul_f32 v70, v246, v25
    v_mul_f32 v71, v247, v25
    v_exp_f32 v64, v64
    v_exp_f32 v65, v65
    v_exp_f32 v66, v66
    v_exp_f32 v67, v67
    v_exp_f32 v68, v68
    v_exp_f32 v69, v69
    v_exp_f32 v70, v70
    v_exp_f32 v71, v71
    s_add_u32 m0, s96, 8192
    s_add_u32 s60, s94, 81920
    buffer_load_dwordx4 v100, s[44:47], s60 offen lds
    v_mul_f32 v240, v240, v248
    v_mul_f32 v241, v241, v249
    v_mul_f32 v242, v242, v250
    v_mul_f32 v243, v243, v251
    v_mul_f32 v244, v244, v252
    v_mul_f32 v245, v245, v253
    v_mul_f32 v246, v246, v254
    v_mul_f32 v247, v247, v255
    v_fma_f32 v64, v64, v23, v23
    v_fma_f32 v65, v65, v23, v23
    v_fma_f32 v66, v66, v23, v23
    v_fma_f32 v67, v67, v23, v23
    v_fma_f32 v68, v68, v23, v23
    v_fma_f32 v69, v69, v23, v23
    v_fma_f32 v70, v70, v23, v23
    v_fma_f32 v71, v71, v23, v23
    v_rcp_f32 v64, v64
    v_rcp_f32 v65, v65
    v_rcp_f32 v66, v66
    v_rcp_f32 v67, v67
    v_rcp_f32 v68, v68
    v_rcp_f32 v69, v69
    v_rcp_f32 v70, v70
    v_rcp_f32 v71, v71
    s_add_u32 m0, s96, 9216
    s_add_u32 s60, s94, 81920
    buffer_load_dwordx4 v101, s[44:47], s60 offen lds
    v_mul_f32 v240, v240, v64
    v_mul_f32 v241, v241, v65
    v_mul_f32 v242, v242, v66
    v_mul_f32 v243, v243, v67
    v_mul_f32 v244, v244, v68
    v_mul_f32 v245, v245, v69
    v_mul_f32 v246, v246, v70
    v_mul_f32 v247, v247, v71
    v_cvt_pk_bf16_f32 v72, v240, v241
    v_cvt_pk_bf16_f32 v73, v242, v243
    v_cvt_pk_bf16_f32 v74, v244, v245
    v_cvt_pk_bf16_f32 v75, v246, v247
    s_cmp_ge_u32 s55, 16
    s_cbranch_scc1 L_ffn_nost
    s_add_u32 s78, s78, 4096
    buffer_store_dwordx4 v[72:75], v26, s[36:39], s78 offen sc1
L_ffn_nost:
    s_waitcnt vmcnt(0)
    s_barrier
    s_lshl_b32 s78, s53, 8
    s_add_u32 s78, s78, 9060352
    s_cmp_eq_u32 s52, 0
    s_cbranch_scc0 L_arr_16
    v_mov_b32 v2, 1
    v_mov_b32 v3, 1073741824
    v_cmp_eq_u32 vcc, 0, v1
    s_nop 1
    v_cndmask_b32 v3, v3, v1, vcc
    buffer_atomic_add v2, v3, s[36:39], s78 offen
L_arr_16:
    s_add_u32 m0, s96, 10240
    s_add_u32 s60, s94, 102400
    buffer_load_dwordx4 v100, s[44:47], s60 offen lds
    s_add_u32 m0, s96, 11264
    s_add_u32 s60, s94, 102400
    buffer_load_dwordx4 v101, s[44:47], s60 offen lds
    s_add_u32 m0, s96, 12288
    s_add_u32 s60, s94, 122880
    buffer_load_dwordx4 v100, s[44:47], s60 offen lds
    s_add_u32 m0, s96, 13312
    s_add_u32 s60, s94, 122880
    buffer_load_dwordx4 v101, s[44:47], s60 offen lds
    s_add_u32 m0, s96, 14336
    s_add_u32 s60, s94, 143360
    buffer_load_dwordx4 v100, s[44:47], s60 offen lds
    s_add_u32 m0, s96, 15360
    s_add_u32 s60, s94, 143360
    buffer_load_dwordx4 v101, s[44:47], s60 offen lds
    s_add_u32 m0, s96, 16384
    s_add_u32 s60, s94, 163840
    buffer_load_dwordx4 v100, s[44:47], s60 offen lds
    s_add_u32 m0, s96, 17408
    s_add_u32 s60, s94, 163840
    buffer_load_dwordx4 v101, s[44:47], s60 offen lds
    s_add_u32 m0, s96, 18432
    s_add_u32 s60, s94, 184320
    buffer_load_dwordx4 v100, s[44:47], s60 offen lds
    s_add_u32 m0, s96, 19456
    s_add_u32 s60, s94, 184320
    buffer_load_dwordx4 v101, s[44:47], s60 offen lds
L_p2:
    s_cmp_eq_u32 s93, 0
    s_cbranch_scc1 L_end
    s_lshr_b32 s57, s88, 1
    s_lshl_b32 s87, s88, 2
    s_cmp_ge_u32 s52, 4
    s_cbranch_scc1 L_p2_helper
    v_lshlrev_b32 v12, 4, v1
    s_mov_b32 s32, s4
    s_mov_b32 s33, s5
    s_mov_b32 s34, 2621440
    s_mov_b32 s35, 0x00020000
    s_mov_b32 s28, s24
    s_mov_b32 s29, s25
    s_mov_b32 s30, 8912896
    s_mov_b32 s31, 0x00020000
    s_add_u32 s81, s87, s52
    s_mul_i32 s58, s81, 136
    s_lshl_b32 s58, s58, 10
    s_mul_i32 s81, s81, 40960
    s_lshl_b32 s60, s89, 7
    s_add_u32 s76, s81, s60
    v_and_b32 v2, 31, v1
    v_mul_u32_u24 v2, 1280, v2
    v_lshrrev_b32 v3, 5, v1
    v_lshl_add_u32 v13, v3, 3, v2
    buffer_load_dwordx2 v[80:81], v13, s[32:35], s76 offen offset:0
    buffer_load_dwordx2 v[82:83], v13, s[32:35], s76 offen offset:16
    buffer_load_dwordx2 v[84:85], v13, s[32:35], s76 offen offset:32
    buffer_load_dwordx2 v[86:87], v13, s[32:35], s76 offen offset:48
    buffer_load_dwordx2 v[88:89], v13, s[32:35], s76 offen offset:64
    buffer_load_dwordx2 v[90:91], v13, s[32:35], s76 offen offset:80
    buffer_load_dwordx2 v[92:93], v13, s[32:35], s76 offen offset:96
    buffer_load_dwordx2 v[94:95], v13, s[32:35], s76 offen offset:112
    v_lshrrev_b32 v2, 5, v1
    v_bfe_u32 v3, v1, 2, 2
    v_lshl_add_u32 v2, v2, 3, v3
    v_lshlrev_b32 v2, 7, v2
    v_bfe_u32 v4, v1, 4, 1
    v_lshlrev_b32 v4, 1, v4
    v_bfe_u32 v5, v1, 1, 1
    v_add_u32 v4, v4, v5
    v_bfe_u32 v5, v3, 1, 1
    v_lshlrev_b32 v5, 2, v5
    v_xor_b32 v4, v4, v5
    v_lshl_add_u32 v2, v4, 4, v2
    v_and_b32 v5, 1, v1
    v_lshl_add_u32 v10, v5, 3, v2
    v_xor_b32 v11, 64, v10
    s_waitcnt vmcnt(0)
    s_barrier
    buffer_load_dwordx4 v[160:163], v12, s[28:31], s58 offen offset:0 sc1
    buffer_load_dwordx4 v[164:167], v12, s[28:31], s58 offen offset:1024 sc1
    buffer_load_dwordx4 v[168:171], v12, s[28:31], s58 offen offset:2048 sc1
    buffer_load_dwordx4 v[172:175], v12, s[28:31], s58 offen offset:3072 sc1
    s_add_u32 s58, s58, 4096
    buffer_load_dwordx4 v[176:179], v12, s[28:31], s58 offen offset:0 sc1
    buffer_load_dwordx4 v[180:183], v12, s[28:31], s58 offen offset:1024 sc1
    buffer_load_dwordx4 v[184:187], v12, s[28:31], s58 offen offset:2048 sc1
    buffer_load_dwordx4 v[188:191], v12, s[28:31], s58 offen offset:3072 sc1
    s_add_u32 s58, s58, 4096
    buffer_load_dwordx4 v[192:195], v12, s[28:31], s58 offen offset:0 sc1
    buffer_load_dwordx4 v[196:199], v12, s[28:31], s58 offen offset:1024 sc1
    buffer_load_dwordx4 v[200:203], v12, s[28:31], s58 offen offset:2048 sc1
    buffer_load_dwordx4 v[204:207], v12, s[28:31], s58 offen offset:3072 sc1
    s_add_u32 s58, s58, 4096
    buffer_load_dwordx4 v[208:211], v12, s[28:31], s58 offen offset:0 sc1
    buffer_load_dwordx4 v[212:215], v12, s[28:31], s58 offen offset:1024 sc1
    buffer_load_dwordx4 v[216:219], v12, s[28:31], s58 offen offset:2048 sc1
    buffer_load_dwordx4 v[220:223], v12, s[28:31], s58 offen offset:3072 sc1
    ds_read_b64_tr_b16 v[64:65], v10 offset:0
    ds_read_b64_tr_b16 v[66:67], v10 offset:512
    ds_read_b64_tr_b16 v[68:69], v11 offset:0
    ds_read_b64_tr_b16 v[70:71], v11 offset:512
    ds_read_b64_tr_b16 v[72:73], v10 offset:2048
    ds_read_b64_tr_b16 v[74:75], v10 offset:2560
    ds_read_b64_tr_b16 v[76:77], v11 offset:2048
    ds_read_b64_tr_b16 v[78:79], v11 offset:2560
    s_waitcnt vmcnt(15) lgkmcnt(6)
    v_mfma_f32_32x32x16_bf16 v[224:239], v[64:67], v[160:163], 0
    ds_read_b64_tr_b16 v[64:65], v10 offset:4096
    ds_read_b64_tr_b16 v[66:67], v10 offset:4608
    s_waitcnt lgkmcnt(6)
    v_mfma_f32_32x32x16_bf16 v[240:255], v[68:71], v[160:163], 0
    s_add_u32 s58, s58, 4096
    buffer_load_dwordx4 v[160:163], v12, s[28:31], s58 offen offset:0 sc1
    ds_read_b64_tr_b16 v[68:69], v11 offset:4096
    ds_read_b64_tr_b16 v[70:71], v11 offset:4608
    s_waitcnt vmcnt(15) lgkmcnt(6)
    v_mfma_f32_32x32x16_bf16 v[224:239], v[72:75], v[164:167], v[224:239]
    ds_read_b64_tr_b16 v[72:73], v10 offset:6144
    ds_read_b64_tr_b16 v[74:75], v10 offset:6656
    s_waitcnt lgkmcnt(6)
    v_mfma_f32_32x32x16_bf16 v[240:255], v[76:79], v[164:167], v[240:255]
    buffer_load_dwordx4 v[164:167], v12, s[28:31], s58 offen offset:1024 sc1
    ds_read_b64_tr_b16 v[76:77], v11 offset:6144
    ds_read_b64_tr_b16 v[78:79], v11 offset:6656
    s_waitcnt vmcnt(15) lgkmcnt(6)
    v_mfma_f32_32x32x16_bf16 v[224:239], v[64:67], v[168:171], v[224:239]
    ds_read_b64_tr_b16 v[64:65], v10 offset:8192
    ds_read_b64_tr_b16 v[66:67], v10 offset:8704
    s_waitcnt lgkmcnt(6)
    v_mfma_f32_32x32x16_bf16 v[240:255], v[68:71], v[168:171], v[240:255]
    buffer_load_dwordx4 v[168:171], v12, s[28:31], s58 offen offset:2048 sc1
    ds_read_b64_tr_b16 v[68:69], v11 offset:8192
    ds_read_b64_tr_b16 v[70:71], v11 offset:8704
    s_waitcnt vmcnt(15) lgkmcnt(6)
    v_mfma_f32_32x32x16_bf16 v[224:239], v[72:75], v[172:175], v[224:239]
    ds_read_b64_tr_b16 v[72:73], v10 offset:10240
    ds_read_b64_tr_b16 v[74:75], v10 offset:10752
    s_waitcnt lgkmcnt(6)
    v_mfma_f32_32x32x16_bf16 v[240:255], v[76:79], v[172:175], v[240:255]
    buffer_load_dwordx4 v[172:175], v12, s[28:31], s58 offen offset:3072 sc1
    ds_read_b64_tr_b16 v[76:77], v11 offset:10240
    ds_read_b64_tr_b16 v[78:79], v11 offset:10752
    s_waitcnt vmcnt(15) lgkmcnt(6)
    v_mfma_f32_32x32x16_bf16 v[224:239], v[64:67], v[176:179], v[224:239]
    ds_read_b64_tr_b16 v[64:65], v10 offset:12288
    ds_read_b64_tr_b16 v[66:67], v10 offset:12800
    s_waitcnt lgkmcnt(6)
    v_mfma_f32_32x32x16_bf16 v[240:255], v[68:71], v[176:179], v[240:255]
    s_add_u32 s58, s58, 4096
    buffer_load_dwordx4 v[176:179], v12, s[28:31], s58 offen offset:0 sc1
    ds_read_b64_tr_b16 v[68:69], v11 offset:12288
    ds_read_b64_tr_b16 v[70:71], v11 offset:12800
    s_waitcnt vmcnt(15) lgkmcnt(6)
    v_mfma_f32_32x32x16_bf16 v[224:239], v[72:75], v[180:183], v[224:239]
    ds_read_b64_tr_b16 v[72:73], v10 offset:14336
    ds_read_b64_tr_b16 v[74:75], v10 offset:14848
    s_waitcnt lgkmcnt(6)
    v_mfma_f32_32x32x16_bf16 v[240:255], v[76:79], v[180:183], v[240:255]
    buffer_load_dwordx4 v[180:183], v12, s[28:31], s58 offen offset:1024 sc1
    ds_read_b64_tr_b16 v[76:77], v11 offset:14336
    ds_read_b64_tr_b16 v[78:79], v11 offset:14848
    s_waitcnt vmcnt(15) lgkmcnt(6)
    v_mfma_f32_32x32x16_bf16 v[224:239], v[64:67], v[184:187], v[224:239]
    ds_read_b64_tr_b16 v[64:65], v10 offset:16384
    ds_read_b64_tr_b16 v[66:67], v10 offset:16896
    s_waitcnt lgkmcnt(6)
    v_mfma_f32_32x32x16_bf16 v[240:255], v[68:71], v[184:187], v[240:255]
    buffer_load_dwordx4 v[184:187], v12, s[28:31], s58 offen offset:2048 sc1
    ds_read_b64_tr_b16 v[68:69], v11 offset:16384
    ds_read_b64_tr_b16 v[70:71], v11 offset:16896
    s_waitcnt vmcnt(15) lgkmcnt(6)
    v_mfma_f32_32x32x16_bf16 v[224:239], v[72:75], v[188:191], v[224:239]
    ds_read_b64_tr_b16 v[72:73], v10 offset:18432
    ds_read_b64_tr_b16 v[74:75], v10 offset:18944
    s_waitcnt lgkmcnt(6)
    v_mfma_f32_32x32x16_bf16 v[240:255], v[76:79], v[188:191], v[240:255]
    buffer_load_dwordx4 v[188:191], v12, s[28:31], s58 offen offset:3072 sc1
    ds_read_b64_tr_b16 v[76:77], v11 offset:18432
    ds_read_b64_tr_b16 v[78:79], v11 offset:18944
    s_waitcnt vmcnt(15) lgkmcnt(6)
    v_mfma_f32_32x32x16_bf16 v[224:239], v[64:67], v[192:195], v[224:239]
    ds_read_b64_tr_b16 v[64:65], v10 offset:20480
    ds_read_b64_tr_b16 v[66:67], v10 offset:20992
    s_waitcnt lgkmcnt(6)
    v_mfma_f32_32x32x16_bf16 v[240:255], v[68:71], v[192:195], v[240:255]
    s_add_u32 s58, s58, 4096
    buffer_load_dwordx4 v[192:195], v12, s[28:31], s58 offen offset:0 sc1
    ds_read_b64_tr_b16 v[68:69], v11 offset:20480
    ds_read_b64_tr_b16 v[70:71], v11 offset:20992
    s_waitcnt vmcnt(15) lgkmcnt(6)
    v_mfma_f32_32x32x16_bf16 v[224:239], v[72:75], v[196:199], v[224:239]
    ds_read_b64_tr_b16 v[72:73], v10 offset:22528
    ds_read_b64_tr_b16 v[74:75], v10 offset:23040
    s_waitcnt lgkmcnt(6)
    v_mfma_f32_32x32x16_bf16 v[240:255], v[76:79], v[196:199], v[240:255]
    buffer_load_dwordx4 v[196:199], v12, s[28:31], s58 offen offset:1024 sc1
    ds_read_b64_tr_b16 v[76:77], v11 offset:22528
    ds_read_b64_tr_b16 v[78:79], v11 offset:23040
    s_waitcnt vmcnt(15) lgkmcnt(6)
    v_mfma_f32_32x32x16_bf16 v[224:239], v[64:67], v[200:203], v[224:239]
    ds_read_b64_tr_b16 v[64:65], v10 offset:24576
    ds_read_b64_tr_b16 v[66:67], v10 offset:25088
    s_waitcnt lgkmcnt(6)
    v_mfma_f32_32x32x16_bf16 v[240:255], v[68:71], v[200:203], v[240:255]
    buffer_load_dwordx4 v[200:203], v12, s[28:31], s58 offen offset:2048 sc1
    ds_read_b64_tr_b16 v[68:69], v11 offset:24576
    ds_read_b64_tr_b16 v[70:71], v11 offset:25088
    s_waitcnt vmcnt(15) lgkmcnt(6)
    v_mfma_f32_32x32x16_bf16 v[224:239], v[72:75], v[204:207], v[224:239]
    ds_read_b64_tr_b16 v[72:73], v10 offset:26624
    ds_read_b64_tr_b16 v[74:75], v10 offset:27136
    s_waitcnt lgkmcnt(6)
    v_mfma_f32_32x32x16_bf16 v[240:255], v[76:79], v[204:207], v[240:255]
    buffer_load_dwordx4 v[204:207], v12, s[28:31], s58 offen offset:3072 sc1
    ds_read_b64_tr_b16 v[76:77], v11 offset:26624
    ds_read_b64_tr_b16 v[78:79], v11 offset:27136
    s_waitcnt vmcnt(15) lgkmcnt(6)
    v_mfma_f32_32x32x16_bf16 v[224:239], v[64:67], v[208:211], v[224:239]
    ds_read_b64_tr_b16 v[64:65], v10 offset:28672
    ds_read_b64_tr_b16 v[66:67], v10 offset:29184
    s_waitcnt lgkmcnt(6)
    v_mfma_f32_32x32x16_bf16 v[240:255], v[68:71], v[208:211], v[240:255]
    s_add_u32 s58, s58, 4096
    buffer_load_dwordx4 v[208:211], v12, s[28:31], s58 offen offset:0 sc1
    ds_read_b64_tr_b16 v[68:69], v11 offset:28672
    ds_read_b64_tr_b16 v[70:71], v11 offset:29184
    s_waitcnt vmcnt(15) lgkmcnt(6)
    v_mfma_f32_32x32x16_bf16 v[224:239], v[72:75], v[212:215], v[224:239]
    ds_read_b64_tr_b16 v[72:73], v10 offset:30720
    ds_read_b64_tr_b16 v[74:75], v10 offset:31232
    s_waitcnt lgkmcnt(6)
    v_mfma_f32_32x32x16_bf16 v[240:255], v[76:79], v[212:215], v[240:255]
    buffer_load_dwordx4 v[212:215], v12, s[28:31], s58 offen offset:1024 sc1
    ds_read_b64_tr_b16 v[76:77], v11 offset:30720
    ds_read_b64_tr_b16 v[78:79], v11 offset:31232
    s_waitcnt vmcnt(15) lgkmcnt(6)
    v_mfma_f32_32x32x16_bf16 v[224:239], v[64:67], v[216:219], v[224:239]
    ds_read_b64_tr_b16 v[64:65], v10 offset:32768
    ds_read_b64_tr_b16 v[66:67], v10 offset:33280
    s_waitcnt lgkmcnt(6)
    v_mfma_f32_32x32x16_bf16 v[240:255], v[68:71], v[216:219], v[240:255]
    buffer_load_dwordx4 v[216:219], v12, s[28:31], s58 offen offset:2048 sc1
    ds_read_b64_tr_b16 v[68:69], v11 offset:32768
    ds_read_b64_tr_b16 v[70:71], v11 offset:33280
    s_waitcnt vmcnt(15) lgkmcnt(6)
    v_mfma_f32_32x32x16_bf16 v[224:239], v[72:75], v[220:223], v[224:239]
    ds_read_b64_tr_b16 v[72:73], v10 offset:34816
    ds_read_b64_tr_b16 v[74:75], v10 offset:35328
    s_waitcnt lgkmcnt(6)
    v_mfma_f32_32x32x16_bf16 v[240:255], v[76:79], v[220:223], v[240:255]
    buffer_load_dwordx4 v[220:223], v12, s[28:31], s58 offen offset:3072 sc1
    ds_read_b64_tr_b16 v[76:77], v11 offset:34816
    ds_read_b64_tr_b16 v[78:79], v11 offset:35328
    s_waitcnt vmcnt(15) lgkmcnt(6)
    v_mfma_f32_32x32x16_bf16 v[224:239], v[64:67], v[160:163], v[224:239]
    ds_read_b64_tr_b16 v[64:65], v10 offset:36864
    ds_read_b64_tr_b16 v[66:67], v10 offset:37376
    s_waitcnt lgkmcnt(6)
    v_mfma_f32_32x32x16_bf16 v[240:255], v[68:71], v[160:163], v[240:255]
    s_add_u32 s58, s58, 4096
    buffer_load_dwordx4 v[160:163], v12, s[28:31], s58 offen offset:0 sc1
    ds_read_b64_tr_b16 v[68:69], v11 offset:36864
    ds_read_b64_tr_b16 v[70:71], v11 offset:37376
    s_waitcnt vmcnt(15) lgkmcnt(6)
    v_mfma_f32_32x32x16_bf16 v[224:239], v[72:75], v[164:167], v[224:239]
    ds_read_b64_tr_b16 v[72:73], v10 offset:38912
    ds_read_b64_tr_b16 v[74:75], v10 offset:39424
    s_waitcnt lgkmcnt(6)
    v_mfma_f32_32x32x16_bf16 v[240:255], v[76:79], v[164:167], v[240:255]
    buffer_load_dwordx4 v[164:167], v12, s[28:31], s58 offen offset:1024 sc1
    ds_read_b64_tr_b16 v[76:77], v11 offset:38912
    ds_read_b64_tr_b16 v[78:79], v11 offset:39424
    s_waitcnt vmcnt(15) lgkmcnt(6)
    v_mfma_f32_32x32x16_bf16 v[224:239], v[64:67], v[168:171], v[224:239]
    ds_read_b64_tr_b16 v[64:65], v10 offset:40960
    ds_read_b64_tr_b16 v[66:67], v10 offset:41472
    s_waitcnt lgkmcnt(6)
    v_mfma_f32_32x32x16_bf16 v[240:255], v[68:71], v[168:171], v[240:255]
    buffer_load_dwordx4 v[168:171], v12, s[28:31], s58 offen offset:2048 sc1
    ds_read_b64_tr_b16 v[68:69], v11 offset:40960
    ds_read_b64_tr_b16 v[70:71], v11 offset:41472
    s_waitcnt vmcnt(15) lgkmcnt(6)
    v_mfma_f32_32x32x16_bf16 v[224:239], v[72:75], v[172:175], v[224:239]
    ds_read_b64_tr_b16 v[72:73], v10 offset:43008
    ds_read_b64_tr_b16 v[74:75], v10 offset:43520
    s_waitcnt lgkmcnt(6)
    v_mfma_f32_32x32x16_bf16 v[240:255], v[76:79], v[172:175], v[240:255]
    buffer_load_dwordx4 v[172:175], v12, s[28:31], s58 offen offset:3072 sc1
    ds_read_b64_tr_b16 v[76:77], v11 offset:43008
    ds_read_b64_tr_b16 v[78:79], v11 offset:43520
    s_waitcnt vmcnt(15) lgkmcnt(6)
    v_mfma_f32_32x32x16_bf16 v[224:239], v[64:67], v[176:179], v[224:239]
    ds_read_b64_tr_b16 v[64:65], v10 offset:45056
    ds_read_b64_tr_b16 v[66:67], v10 offset:45568
    s_waitcnt lgkmcnt(6)
    v_mfma_f32_32x32x16_bf16 v[240:255], v[68:71], v[176:179], v[240:255]
    s_add_u32 s58, s58, 4096
    buffer_load_dwordx4 v[176:179], v12, s[28:31], s58 offen offset:0 sc1
    ds_read_b64_tr_b16 v[68:69], v11 offset:45056
    ds_read_b64_tr_b16 v[70:71], v11 offset:45568
    s_waitcnt vmcnt(15) lgkmcnt(6)
    v_mfma_f32_32x32x16_bf16 v[224:239], v[72:75], v[180:183], v[224:239]
    ds_read_b64_tr_b16 v[72:73], v10 offset:47104
    ds_read_b64_tr_b16 v[74:75], v10 offset:47616
    s_waitcnt lgkmcnt(6)
    v_mfma_f32_32x32x16_bf16 v[240:255], v[76:79], v[180:183], v[240:255]
    buffer_load_dwordx4 v[180:183], v12, s[28:31], s58 offen offset:1024 sc1
    ds_read_b64_tr_b16 v[76:77], v11 offset:47104
    ds_read_b64_tr_b16 v[78:79], v11 offset:47616
    s_waitcnt vmcnt(15) lgkmcnt(6)
    v_mfma_f32_32x32x16_bf16 v[224:239], v[64:67], v[184:187], v[224:239]
    ds_read_b64_tr_b16 v[64:65], v10 offset:49152
    ds_read_b64_tr_b16 v[66:67], v10 offset:49664
    s_waitcnt lgkmcnt(6)
    v_mfma_f32_32x32x16_bf16 v[240:255], v[68:71], v[184:187], v[240:255]
    buffer_load_dwordx4 v[184:187], v12, s[28:31], s58 offen offset:2048 sc1
    ds_read_b64_tr_b16 v[68:69], v11 offset:49152
    ds_read_b64_tr_b16 v[70:71], v11 offset:49664
    s_waitcnt vmcnt(15) lgkmcnt(6)
    v_mfma_f32_32x32x16_bf16 v[224:239], v[72:75], v[188:191], v[224:239]
    ds_read_b64_tr_b16 v[72:73], v10 offset:51200
    ds_read_b64_tr_b16 v[74:75], v10 offset:51712
    s_waitcnt lgkmcnt(6)
    v_mfma_f32_32x32x16_bf16 v[240:255], v[76:79], v[188:191], v[240:255]
    buffer_load_dwordx4 v[188:191], v12, s[28:31], s58 offen offset:3072 sc1
    ds_read_b64_tr_b16 v[76:77], v11 offset:51200
    ds_read_b64_tr_b16 v[78:79], v11 offset:51712
    s_barrier
    s_waitcnt vmcnt(15) lgkmcnt(6)
    v_mfma_f32_32x32x16_bf16 v[224:239], v[64:67], v[192:195], v[224:239]
    ds_read_b64_tr_b16 v[64:65], v10 offset:53248
    ds_read_b64_tr_b16 v[66:67], v10 offset:53760
    s_waitcnt lgkmcnt(6)
    v_mfma_f32_32x32x16_bf16 v[240:255], v[68:71], v[192:195], v[240:255]
    s_add_u32 s58, s58, 4096
    buffer_load_dwordx4 v[192:195], v12, s[28:31], s58 offen offset:0 sc1
    ds_read_b64_tr_b16 v[68:69], v11 offset:53248
    ds_read_b64_tr_b16 v[70:71], v11 offset:53760
    s_waitcnt vmcnt(15) lgkmcnt(6)
    v_mfma_f32_32x32x16_bf16 v[224:239], v[72:75], v[196:199], v[224:239]
    ds_read_b64_tr_b16 v[72:73], v10 offset:55296
    ds_read_b64_tr_b16 v[74:75], v10 offset:55808
    s_waitcnt lgkmcnt(6)
    v_mfma_f32_32x32x16_bf16 v[240:255], v[76:79], v[196:199], v[240:255]
    buffer_load_dwordx4 v[196:199], v12, s[28:31], s58 offen offset:1024 sc1
    ds_read_b64_tr_b16 v[76:77], v11 offset:55296
    ds_read_b64_tr_b16 v[78:79], v11 offset:55808
    s_waitcnt vmcnt(15) lgkmcnt(6)
    v_mfma_f32_32x32x16_bf16 v[224:239], v[64:67], v[200:203], v[224:239]
    ds_read_b64_tr_b16 v[64:65], v10 offset:57344
    ds_read_b64_tr_b16 v[66:67], v10 offset:57856
    s_waitcnt lgkmcnt(6)
    v_mfma_f32_32x32x16_bf16 v[240:255], v[68:71], v[200:203], v[240:255]
    buffer_load_dwordx4 v[200:203], v12, s[28:31], s58 offen offset:2048 sc1
    ds_read_b64_tr_b16 v[68:69], v11 offset:57344
    ds_read_b64_tr_b16 v[70:71], v11 offset:57856
    s_waitcnt vmcnt(15) lgkmcnt(6)
    v_mfma_f32_32x32x16_bf16 v[224:239], v[72:75], v[204:207], v[224:239]
    ds_read_b64_tr_b16 v[72:73], v10 offset:59392
    ds_read_b64_tr_b16 v[74:75], v10 offset:59904
    s_waitcnt lgkmcnt(6)
    v_mfma_f32_32x32x16_bf16 v[240:255], v[76:79], v[204:207], v[240:255]
    buffer_load_dwordx4 v[204:207], v12, s[28:31], s58 offen offset:3072 sc1
    ds_read_b64_tr_b16 v[76:77], v11 offset:59392
    ds_read_b64_tr_b16 v[78:79], v11 offset:59904
    s_waitcnt vmcnt(15) lgkmcnt(6)
    v_mfma_f32_32x32x16_bf16 v[224:239], v[64:67], v[208:211], v[224:239]
    ds_read_b64_tr_b16 v[64:65], v10 offset:61440
    ds_read_b64_tr_b16 v[66:67], v10 offset:61952
    s_waitcnt lgkmcnt(6)
    v_mfma_f32_32x32x16_bf16 v[240:255], v[68:71], v[208:211], v[240:255]
    s_add_u32 s58, s58, 4096
    buffer_load_dwordx4 v[208:211], v12, s[28:31], s58 offen offset:0 sc1
    ds_read_b64_tr_b16 v[68:69], v11 offset:61440
    ds_read_b64_tr_b16 v[70:71], v11 offset:61952
    s_waitcnt vmcnt(15) lgkmcnt(6)
    v_mfma_f32_32x32x16_bf16 v[224:239], v[72:75], v[212:215], v[224:239]
    ds_read_b64_tr_b16 v[72:73], v10 offset:63488
    ds_read_b64_tr_b16 v[74:75], v10 offset:64000
    s_waitcnt lgkmcnt(6)
    v_mfma_f32_32x32x16_bf16 v[240:255], v[76:79], v[212:215], v[240:255]
    buffer_load_dwordx4 v[212:215], v12, s[28:31], s58 offen offset:1024 sc1
    ds_read_b64_tr_b16 v[76:77], v11 offset:63488
    ds_read_b64_tr_b16 v[78:79], v11 offset:64000
    s_waitcnt vmcnt(15) lgkmcnt(6)
    v_mfma_f32_32x32x16_bf16 v[224:239], v[64:67], v[216:219], v[224:239]
    v_add_u32 v10, 0x10000, v10
    v_add_u32 v11, 0x10000, v11
    ds_read_b64_tr_b16 v[64:65], v10 offset:0
    ds_read_b64_tr_b16 v[66:67], v10 offset:512
    s_waitcnt lgkmcnt(6)
    v_mfma_f32_32x32x16_bf16 v[240:255], v[68:71], v[216:219], v[240:255]
    buffer_load_dwordx4 v[216:219], v12, s[28:31], s58 offen offset:2048 sc1
    ds_read_b64_tr_b16 v[68:69], v11 offset:0
    ds_read_b64_tr_b16 v[70:71], v11 offset:512
    s_waitcnt vmcnt(15) lgkmcnt(6)
    v_mfma_f32_32x32x16_bf16 v[224:239], v[72:75], v[220:223], v[224:239]
    ds_read_b64_tr_b16 v[72:73], v10 offset:2048
    ds_read_b64_tr_b16 v[74:75], v10 offset:2560
    s_waitcnt lgkmcnt(6)
    v_mfma_f32_32x32x16_bf16 v[240:255], v[76:79], v[220:223], v[240:255]
    buffer_load_dwordx4 v[220:223], v12, s[28:31], s58 offen offset:3072 sc1
    ds_read_b64_tr_b16 v[76:77], v11 offset:2048
    ds_read_b64_tr_b16 v[78:79], v11 offset:2560
    s_waitcnt vmcnt(15) lgkmcnt(6)
    v_mfma_f32_32x32x16_bf16 v[224:239], v[64:67], v[160:163], v[224:239]
    ds_read_b64_tr_b16 v[64:65], v10 offset:4096
    ds_read_b64_tr_b16 v[66:67], v10 offset:4608
    s_waitcnt lgkmcnt(6)
    v_mfma_f32_32x32x16_bf16 v[240:255], v[68:71], v[160:163], v[240:255]
    s_add_u32 s58, s58, 4096
    buffer_load_dwordx4 v[160:163], v12, s[28:31], s58 offen offset:0 sc1
    ds_read_b64_tr_b16 v[68:69], v11 offset:4096
    ds_read_b64_tr_b16 v[70:71], v11 offset:4608
    s_waitcnt vmcnt(15) lgkmcnt(6)
    v_mfma_f32_32x32x16_bf16 v[224:239], v[72:75], v[164:167], v[224:239]
    ds_read_b64_tr_b16 v[72:73], v10 offset:6144
    ds_read_b64_tr_b16 v[74:75], v10 offset:6656
    s_waitcnt lgkmcnt(6)
    v_mfma_f32_32x32x16_bf16 v[240:255], v[76:79], v[164:167], v[240:255]
    buffer_load_dwordx4 v[164:167], v12, s[28:31], s58 offen offset:1024 sc1
    ds_read_b64_tr_b16 v[76:77], v11 offset:6144
    ds_read_b64_tr_b16 v[78:79], v11 offset:6656
    s_waitcnt vmcnt(15) lgkmcnt(6)
    v_mfma_f32_32x32x16_bf16 v[224:239], v[64:67], v[168:171], v[224:239]
    ds_read_b64_tr_b16 v[64:65], v10 offset:8192
    ds_read_b64_tr_b16 v[66:67], v10 offset:8704
    s_waitcnt lgkmcnt(6)
    v_mfma_f32_32x32x16_bf16 v[240:255], v[68:71], v[168:171], v[240:255]
    buffer_load_dwordx4 v[168:171], v12, s[28:31], s58 offen offset:2048 sc1
    ds_read_b64_tr_b16 v[68:69], v11 offset:8192
    ds_read_b64_tr_b16 v[70:71], v11 offset:8704
    s_waitcnt vmcnt(15) lgkmcnt(6)
    v_mfma_f32_32x32x16_bf16 v[224:239], v[72:75], v[172:175], v[224:239]
    ds_read_b64_tr_b16 v[72:73], v10 offset:10240
    ds_read_b64_tr_b16 v[74:75], v10 offset:10752
    s_waitcnt lgkmcnt(6)
    v_mfma_f32_32x32x16_bf16 v[240:255], v[76:79], v[172:175], v[240:255]
    buffer_load_dwordx4 v[172:175], v12, s[28:31], s58 offen offset:3072 sc1
    ds_read_b64_tr_b16 v[76:77], v11 offset:10240
    ds_read_b64_tr_b16 v[78:79], v11 offset:10752
    s_waitcnt vmcnt(15) lgkmcnt(6)
    v_mfma_f32_32x32x16_bf16 v[224:239], v[64:67], v[176:179], v[224:239]
    ds_read_b64_tr_b16 v[64:65], v10 offset:12288
    ds_read_b64_tr_b16 v[66:67], v10 offset:12800
    s_waitcnt lgkmcnt(6)
    v_mfma_f32_32x32x16_bf16 v[240:255], v[68:71], v[176:179], v[240:255]
    s_add_u32 s58, s58, 4096
    buffer_load_dwordx4 v[176:179], v12, s[28:31], s58 offen offset:0 sc1
    ds_read_b64_tr_b16 v[68:69], v11 offset:12288
    ds_read_b64_tr_b16 v[70:71], v11 offset:12800
    s_waitcnt vmcnt(15) lgkmcnt(6)
    v_mfma_f32_32x32x16_bf16 v[224:239], v[72:75], v[180:183], v[224:239]
    ds_read_b64_tr_b16 v[72:73], v10 offset:14336
    ds_read_b64_tr_b16 v[74:75], v10 offset:14848
    s_waitcnt lgkmcnt(6)
    v_mfma_f32_32x32x16_bf16 v[240:255], v[76:79], v[180:183], v[240:255]
    buffer_load_dwordx4 v[180:183], v12, s[28:31], s58 offen offset:1024 sc1
    ds_read_b64_tr_b16 v[76:77], v11 offset:14336
    ds_read_b64_tr_b16 v[78:79], v11 offset:14848
    s_waitcnt vmcnt(15) lgkmcnt(6)
    v_mfma_f32_32x32x16_bf16 v[224:239], v[64:67], v[184:187], v[224:239]
    ds_read_b64_tr_b16 v[64:65], v10 offset:16384
    ds_read_b64_tr_b16 v[66:67], v10 offset:16896
    s_waitcnt lgkmcnt(6)
    v_mfma_f32_32x32x16_bf16 v[240:255], v[68:71], v[184:187], v[240:255]
    buffer_load_dwordx4 v[184:187], v12, s[28:31], s58 offen offset:2048 sc1
    ds_read_b64_tr_b16 v[68:69], v11 offset:16384
    ds_read_b64_tr_b16 v[70:71], v11 offset:16896
    s_waitcnt vmcnt(15) lgkmcnt(6)
    v_mfma_f32_32x32x16_bf16 v[224:239], v[72:75], v[188:191], v[224:239]
    ds_read_b64_tr_b16 v[72:73], v10 offset:18432
    ds_read_b64_tr_b16 v[74:75], v10 offset:18944
    s_waitcnt lgkmcnt(6)
    v_mfma_f32_32x32x16_bf16 v[240:255], v[76:79], v[188:191], v[240:255]
    buffer_load_dwordx4 v[188:191], v12, s[28:31], s58 offen offset:3072 sc1
    ds_read_b64_tr_b16 v[76:77], v11 offset:18432
    ds_read_b64_tr_b16 v[78:79], v11 offset:18944
    s_waitcnt vmcnt(15) lgkmcnt(6)
    v_mfma_f32_32x32x16_bf16 v[224:239], v[64:67], v[192:195], v[224:239]
    ds_read_b64_tr_b16 v[64:65], v10 offset:20480
    ds_read_b64_tr_b16 v[66:67], v10 offset:20992
    s_waitcnt lgkmcnt(6)
    v_mfma_f32_32x32x16_bf16 v[240:255], v[68:71], v[192:195], v[240:255]
    s_add_u32 s58, s58, 4096
    buffer_load_dwordx4 v[192:195], v12, s[28:31], s58 offen offset:0 sc1
    ds_read_b64_tr_b16 v[68:69], v11 offset:20480
    ds_read_b64_tr_b16 v[70:71], v11 offset:20992
    s_waitcnt vmcnt(15) lgkmcnt(6)
    v_mfma_f32_32x32x16_bf16 v[224:239], v[72:75], v[196:199], v[224:239]
    ds_read_b64_tr_b16 v[72:73], v10 offset:22528
    ds_read_b64_tr_b16 v[74:75], v10 offset:23040
    s_waitcnt lgkmcnt(6)
    v_mfma_f32_32x32x16_bf16 v[240:255], v[76:79], v[196:199], v[240:255]
    buffer_load_dwordx4 v[196:199], v12, s[28:31], s58 offen offset:1024 sc1
    ds_read_b64_tr_b16 v[76:77], v11 offset:22528
    ds_read_b64_tr_b16 v[78:79], v11 offset:23040
    s_waitcnt vmcnt(15) lgkmcnt(6)
    v_mfma_f32_32x32x16_bf16 v[224:239], v[64:67], v[200:203], v[224:239]
    ds_read_b64_tr_b16 v[64:65], v10 offset:24576
    ds_read_b64_tr_b16 v[66:67], v10 offset:25088
    s_waitcnt lgkmcnt(6)
    v_mfma_f32_32x32x16_bf16 v[240:255], v[68:71], v[200:203], v[240:255]
    buffer_load_dwordx4 v[200:203], v12, s[28:31], s58 offen offset:2048 sc1
    ds_read_b64_tr_b16 v[68:69], v11 offset:24576
    ds_read_b64_tr_b16 v[70:71], v11 offset:25088
    s_waitcnt vmcnt(15) lgkmcnt(6)
    v_mfma_f32_32x32x16_bf16 v[224:239], v[72:75], v[204:207], v[224:239]
    ds_read_b64_tr_b16 v[72:73], v10 offset:26624
    ds_read_b64_tr_b16 v[74:75], v10 offset:27136
    s_waitcnt lgkmcnt(6)
    v_mfma_f32_32x32x16_bf16 v[240:255], v[76:79], v[204:207], v[240:255]
    buffer_load_dwordx4 v[204:207], v12, s[28:31], s58 offen offset:3072 sc1
    ds_read_b64_tr_b16 v[76:77], v11 offset:26624
    ds_read_b64_tr_b16 v[78:79], v11 offset:27136
    s_waitcnt vmcnt(15) lgkmcnt(6)
    v_mfma_f32_32x32x16_bf16 v[224:239], v[64:67], v[208:211], v[224:239]
    ds_read_b64_tr_b16 v[64:65], v10 offset:28672
    ds_read_b64_tr_b16 v[66:67], v10 offset:29184
    s_waitcnt lgkmcnt(6)
    v_mfma_f32_32x32x16_bf16 v[240:255], v[68:71], v[208:211], v[240:255]
    s_add_u32 s58, s58, 4096
    buffer_load_dwordx4 v[208:211], v12, s[28:31], s58 offen offset:0 sc1
    ds_read_b64_tr_b16 v[68:69], v11 offset:28672
    ds_read_b64_tr_b16 v[70:71], v11 offset:29184
    s_waitcnt vmcnt(15) lgkmcnt(6)
    v_mfma_f32_32x32x16_bf16 v[224:239], v[72:75], v[212:215], v[224:239]
    ds_read_b64_tr_b16 v[72:73], v10 offset:30720
    ds_read_b64_tr_b16 v[74:75], v10 offset:31232
    s_waitcnt lgkmcnt(6)
    v_mfma_f32_32x32x16_bf16 v[240:255], v[76:79], v[212:215], v[240:255]
    buffer_load_dwordx4 v[212:215], v12, s[28:31], s58 offen offset:1024 sc1
    ds_read_b64_tr_b16 v[76:77], v11 offset:30720
    ds_read_b64_tr_b16 v[78:79], v11 offset:31232
    s_waitcnt vmcnt(15) lgkmcnt(6)
    v_mfma_f32_32x32x16_bf16 v[224:239], v[64:67], v[216:219], v[224:239]
    ds_read_b64_tr_b16 v[64:65], v10 offset:32768
    ds_read_b64_tr_b16 v[66:67], v10 offset:33280
    s_waitcnt lgkmcnt(6)
    v_mfma_f32_32x32x16_bf16 v[240:255], v[68:71], v[216:219], v[240:255]
    buffer_load_dwordx4 v[216:219], v12, s[28:31], s58 offen offset:2048 sc1
    ds_read_b64_tr_b16 v[68:69], v11 offset:32768
    ds_read_b64_tr_b16 v[70:71], v11 offset:33280
    s_waitcnt vmcnt(15) lgkmcnt(6)
    v_mfma_f32_32x32x16_bf16 v[224:239], v[72:75], v[220:223], v[224:239]
    ds_read_b64_tr_b16 v[72:73], v10 offset:34816
    ds_read_b64_tr_b16 v[74:75], v10 offset:35328
    s_waitcnt lgkmcnt(6)
    v_mfma_f32_32x32x16_bf16 v[240:255], v[76:79], v[220:223], v[240:255]
    buffer_load_dwordx4 v[220:223], v12, s[28:31], s58 offen offset:3072 sc1
    ds_read_b64_tr_b16 v[76:77], v11 offset:34816
    ds_read_b64_tr_b16 v[78:79], v11 offset:35328
    s_barrier
    s_waitcnt vmcnt(15) lgkmcnt(6)
    v_mfma_f32_32x32x16_bf16 v[224:239], v[64:67], v[160:163], v[224:239]
    ds_read_b64_tr_b16 v[64:65], v10 offset:36864
    ds_read_b64_tr_b16 v[66:67], v10 offset:37376
    s_waitcnt lgkmcnt(6)
    v_mfma_f32_32x32x16_bf16 v[240:255], v[68:71], v[160:163], v[240:255]
    s_add_u32 s58, s58, 4096
    buffer_load_dwordx4 v[160:163], v12, s[28:31], s58 offen offset:0 sc1
    ds_read_b64_tr_b16 v[68:69], v11 offset:36864
    ds_read_b64_tr_b16 v[70:71], v11 offset:37376
    s_waitcnt vmcnt(15) lgkmcnt(6)
    v_mfma_f32_32x32x16_bf16 v[224:239], v[72:75], v[164:167], v[224:239]
    ds_read_b64_tr_b16 v[72:73], v10 offset:38912
    ds_read_b64_tr_b16 v[74:75], v10 offset:39424
    s_waitcnt lgkmcnt(6)
    v_mfma_f32_32x32x16_bf16 v[240:255], v[76:79], v[164:167], v[240:255]
    buffer_load_dwordx4 v[164:167], v12, s[28:31], s58 offen offset:1024 sc1
    ds_read_b64_tr_b16 v[76:77], v11 offset:38912
    ds_read_b64_tr_b16 v[78:79], v11 offset:39424
    s_waitcnt vmcnt(15) lgkmcnt(6)
    v_mfma_f32_32x32x16_bf16 v[224:239], v[64:67], v[168:171], v[224:239]
    ds_read_b64_tr_b16 v[64:65], v10 offset:40960
    ds_read_b64_tr_b16 v[66:67], v10 offset:41472
    s_waitcnt lgkmcnt(6)
    v_mfma_f32_32x32x16_bf16 v[240:255], v[68:71], v[168:171], v[240:255]
    buffer_load_dwordx4 v[168:171], v12, s[28:31], s58 offen offset:2048 sc1
    ds_read_b64_tr_b16 v[68:69], v11 offset:40960
    ds_read_b64_tr_b16 v[70:71], v11 offset:41472
    s_waitcnt vmcnt(15) lgkmcnt(6)
    v_mfma_f32_32x32x16_bf16 v[224:239], v[72:75], v[172:175], v[224:239]
    ds_read_b64_tr_b16 v[72:73], v10 offset:43008
    ds_read_b64_tr_b16 v[74:75], v10 offset:43520
    s_waitcnt lgkmcnt(6)
    v_mfma_f32_32x32x16_bf16 v[240:255], v[76:79], v[172:175], v[240:255]
    buffer_load_dwordx4 v[172:175], v12, s[28:31], s58 offen offset:3072 sc1
    ds_read_b64_tr_b16 v[76:77], v11 offset:43008
    ds_read_b64_tr_b16 v[78:79], v11 offset:43520
    s_waitcnt vmcnt(15) lgkmcnt(6)
    v_mfma_f32_32x32x16_bf16 v[224:239], v[64:67], v[176:179], v[224:239]
    ds_read_b64_tr_b16 v[64:65], v10 offset:45056
    ds_read_b64_tr_b16 v[66:67], v10 offset:45568
    s_waitcnt lgkmcnt(6)
    v_mfma_f32_32x32x16_bf16 v[240:255], v[68:71], v[176:179], v[240:255]
    s_add_u32 s58, s58, 4096
    buffer_load_dwordx4 v[176:179], v12, s[28:31], s58 offen offset:0 sc1
    ds_read_b64_tr_b16 v[68:69], v11 offset:45056
    ds_read_b64_tr_b16 v[70:71], v11 offset:45568
    s_waitcnt vmcnt(15) lgkmcnt(6)
    v_mfma_f32_32x32x16_bf16 v[224:239], v[72:75], v[180:183], v[224:239]
    ds_read_b64_tr_b16 v[72:73], v10 offset:47104
    ds_read_b64_tr_b16 v[74:75], v10 offset:47616
    s_waitcnt lgkmcnt(6)
    v_mfma_f32_32x32x16_bf16 v[240:255], v[76:79], v[180:183], v[240:255]
    buffer_load_dwordx4 v[180:183], v12, s[28:31], s58 offen offset:1024 sc1
    ds_read_b64_tr_b16 v[76:77], v11 offset:47104
    ds_read_b64_tr_b16 v[78:79], v11 offset:47616
    s_waitcnt vmcnt(15) lgkmcnt(6)
    v_mfma_f32_32x32x16_bf16 v[224:239], v[64:67], v[184:187], v[224:239]
    ds_read_b64_tr_b16 v[64:65], v10 offset:49152
    ds_read_b64_tr_b16 v[66:67], v10 offset:49664
    s_waitcnt lgkmcnt(6)
    v_mfma_f32_32x32x16_bf16 v[240:255], v[68:71], v[184:187], v[240:255]
    buffer_load_dwordx4 v[184:187], v12, s[28:31], s58 offen offset:2048 sc1
    ds_read_b64_tr_b16 v[68:69], v11 offset:49152
    ds_read_b64_tr_b16 v[70:71], v11 offset:49664
    s_waitcnt vmcnt(15) lgkmcnt(6)
    v_mfma_f32_32x32x16_bf16 v[224:239], v[72:75], v[188:191], v[224:239]
    ds_read_b64_tr_b16 v[72:73], v10 offset:51200
    ds_read_b64_tr_b16 v[74:75], v10 offset:51712
    s_waitcnt lgkmcnt(6)
    v_mfma_f32_32x32x16_bf16 v[240:255], v[76:79], v[188:191], v[240:255]
    buffer_load_dwordx4 v[188:191], v12, s[28:31], s58 offen offset:3072 sc1
    ds_read_b64_tr_b16 v[76:77], v11 offset:51200
    ds_read_b64_tr_b16 v[78:79], v11 offset:51712
    s_waitcnt vmcnt(15) lgkmcnt(6)
    v_mfma_f32_32x32x16_bf16 v[224:239], v[64:67], v[192:195], v[224:239]
    ds_read_b64_tr_b16 v[64:65], v10 offset:53248
    ds_read_b64_tr_b16 v[66:67], v10 offset:53760
    s_waitcnt lgkmcnt(6)
    v_mfma_f32_32x32x16_bf16 v[240:255], v[68:71], v[192:195], v[240:255]
    s_add_u32 s58, s58, 4096
    buffer_load_dwordx4 v[192:195], v12, s[28:31], s58 offen offset:0 sc1
    ds_read_b64_tr_b16 v[68:69], v11 offset:53248
    ds_read_b64_tr_b16 v[70:71], v11 offset:53760
    s_waitcnt vmcnt(15) lgkmcnt(6)
    v_mfma_f32_32x32x16_bf16 v[224:239], v[72:75], v[196:199], v[224:239]
    ds_read_b64_tr_b16 v[72:73], v10 offset:55296
    ds_read_b64_tr_b16 v[74:75], v10 offset:55808
    s_waitcnt lgkmcnt(6)
    v_mfma_f32_32x32x16_bf16 v[240:255], v[76:79], v[196:199], v[240:255]
    buffer_load_dwordx4 v[196:199], v12, s[28:31], s58 offen offset:1024 sc1
    ds_read_b64_tr_b16 v[76:77], v11 offset:55296
    ds_read_b64_tr_b16 v[78:79], v11 offset:55808
    s_waitcnt vmcnt(15) lgkmcnt(6)
    v_mfma_f32_32x32x16_bf16 v[224:239], v[64:67], v[200:203], v[224:239]
    ds_read_b64_tr_b16 v[64:65], v10 offset:57344
    ds_read_b64_tr_b16 v[66:67], v10 offset:57856
    s_waitcnt lgkmcnt(6)
    v_mfma_f32_32x32x16_bf16 v[240:255], v[68:71], v[200:203], v[240:255]
    buffer_load_dwordx4 v[200:203], v12, s[28:31], s58 offen offset:2048 sc1
    ds_read_b64_tr_b16 v[68:69], v11 offset:57344
    ds_read_b64_tr_b16 v[70:71], v11 offset:57856
    s_waitcnt vmcnt(15) lgkmcnt(6)
    v_mfma_f32_32x32x16_bf16 v[224:239], v[72:75], v[204:207], v[224:239]
    ds_read_b64_tr_b16 v[72:73], v10 offset:59392
    ds_read_b64_tr_b16 v[74:75], v10 offset:59904
    s_waitcnt lgkmcnt(6)
    v_mfma_f32_32x32x16_bf16 v[240:255], v[76:79], v[204:207], v[240:255]
    buffer_load_dwordx4 v[204:207], v12, s[28:31], s58 offen offset:3072 sc1
    ds_read_b64_tr_b16 v[76:77], v11 offset:59392
    ds_read_b64_tr_b16 v[78:79], v11 offset:59904
    s_waitcnt vmcnt(15) lgkmcnt(6)
    v_mfma_f32_32x32x16_bf16 v[224:239], v[64:67], v[208:211], v[224:239]
    ds_read_b64_tr_b16 v[64:65], v10 offset:61440
    ds_read_b64_tr_b16 v[66:67], v10 offset:61952
    s_waitcnt lgkmcnt(6)
    v_mfma_f32_32x32x16_bf16 v[240:255], v[68:71], v[208:211], v[240:255]
    s_add_u32 s58, s58, 4096
    buffer_load_dwordx4 v[208:211], v12, s[28:31], s58 offen offset:0 sc1
    ds_read_b64_tr_b16 v[68:69], v11 offset:61440
    ds_read_b64_tr_b16 v[70:71], v11 offset:61952
    s_waitcnt vmcnt(15) lgkmcnt(6)
    v_mfma_f32_32x32x16_bf16 v[224:239], v[72:75], v[212:215], v[224:239]
    ds_read_b64_tr_b16 v[72:73], v10 offset:63488
    ds_read_b64_tr_b16 v[74:75], v10 offset:64000
    s_waitcnt lgkmcnt(6)
    v_mfma_f32_32x32x16_bf16 v[240:255], v[76:79], v[212:215], v[240:255]
    buffer_load_dwordx4 v[212:215], v12, s[28:31], s58 offen offset:1024 sc1
    ds_read_b64_tr_b16 v[76:77], v11 offset:63488
    ds_read_b64_tr_b16 v[78:79], v11 offset:64000
    s_waitcnt vmcnt(15) lgkmcnt(6)
    v_mfma_f32_32x32x16_bf16 v[224:239], v[64:67], v[216:219], v[224:239]
    v_add_u32 v10, 0x10000, v10
    v_add_u32 v11, 0x10000, v11
    ds_read_b64_tr_b16 v[64:65], v10 offset:0
    ds_read_b64_tr_b16 v[66:67], v10 offset:512
    s_waitcnt lgkmcnt(6)
    v_mfma_f32_32x32x16_bf16 v[240:255], v[68:71], v[216:219], v[240:255]
    buffer_load_dwordx4 v[216:219], v12, s[28:31], s58 offen offset:2048 sc1
    ds_read_b64_tr_b16 v[68:69], v11 offset:0
    ds_read_b64_tr_b16 v[70:71], v11 offset:512
    s_waitcnt vmcnt(15) lgkmcnt(6)
    v_mfma_f32_32x32x16_bf16 v[224:239], v[72:75], v[220:223], v[224:239]
    ds_read_b64_tr_b16 v[72:73], v10 offset:2048
    ds_read_b64_tr_b16 v[74:75], v10 offset:2560
    s_waitcnt lgkmcnt(6)
    v_mfma_f32_32x32x16_bf16 v[240:255], v[76:79], v[220:223], v[240:255]
    buffer_load_dwordx4 v[220:223], v12, s[28:31], s58 offen offset:3072 sc1
    ds_read_b64_tr_b16 v[76:77], v11 offset:2048
    ds_read_b64_tr_b16 v[78:79], v11 offset:2560
    s_waitcnt vmcnt(15) lgkmcnt(6)
    v_mfma_f32_32x32x16_bf16 v[224:239], v[64:67], v[160:163], v[224:239]
    ds_read_b64_tr_b16 v[64:65], v10 offset:4096
    ds_read_b64_tr_b16 v[66:67], v10 offset:4608
    s_waitcnt lgkmcnt(6)
    v_mfma_f32_32x32x16_bf16 v[240:255], v[68:71], v[160:163], v[240:255]
    s_add_u32 s58, s58, 4096
    buffer_load_dwordx4 v[160:163], v12, s[28:31], s58 offen offset:0 sc1
    ds_read_b64_tr_b16 v[68:69], v11 offset:4096
    ds_read_b64_tr_b16 v[70:71], v11 offset:4608
    s_waitcnt vmcnt(15) lgkmcnt(6)
    v_mfma_f32_32x32x16_bf16 v[224:239], v[72:75], v[164:167], v[224:239]
    ds_read_b64_tr_b16 v[72:73], v10 offset:6144
    ds_read_b64_tr_b16 v[74:75], v10 offset:6656
    s_waitcnt lgkmcnt(6)
    v_mfma_f32_32x32x16_bf16 v[240:255], v[76:79], v[164:167], v[240:255]
    buffer_load_dwordx4 v[164:167], v12, s[28:31], s58 offen offset:1024 sc1
    ds_read_b64_tr_b16 v[76:77], v11 offset:6144
    ds_read_b64_tr_b16 v[78:79], v11 offset:6656
    s_waitcnt vmcnt(15) lgkmcnt(6)
    v_mfma_f32_32x32x16_bf16 v[224:239], v[64:67], v[168:171], v[224:239]
    ds_read_b64_tr_b16 v[64:65], v10 offset:8192
    ds_read_b64_tr_b16 v[66:67], v10 offset:8704
    s_waitcnt lgkmcnt(6)
    v_mfma_f32_32x32x16_bf16 v[240:255], v[68:71], v[168:171], v[240:255]
    buffer_load_dwordx4 v[168:171], v12, s[28:31], s58 offen offset:2048 sc1
    ds_read_b64_tr_b16 v[68:69], v11 offset:8192
    ds_read_b64_tr_b16 v[70:71], v11 offset:8704
    s_waitcnt vmcnt(15) lgkmcnt(6)
    v_mfma_f32_32x32x16_bf16 v[224:239], v[72:75], v[172:175], v[224:239]
    ds_read_b64_tr_b16 v[72:73], v10 offset:10240
    ds_read_b64_tr_b16 v[74:75], v10 offset:10752
    s_waitcnt lgkmcnt(6)
    v_mfma_f32_32x32x16_bf16 v[240:255], v[76:79], v[172:175], v[240:255]
    buffer_load_dwordx4 v[172:175], v12, s[28:31], s58 offen offset:3072 sc1
    ds_read_b64_tr_b16 v[76:77], v11 offset:10240
    ds_read_b64_tr_b16 v[78:79], v11 offset:10752
    s_waitcnt vmcnt(15) lgkmcnt(6)
    v_mfma_f32_32x32x16_bf16 v[224:239], v[64:67], v[176:179], v[224:239]
    ds_read_b64_tr_b16 v[64:65], v10 offset:12288
    ds_read_b64_tr_b16 v[66:67], v10 offset:12800
    s_waitcnt lgkmcnt(6)
    v_mfma_f32_32x32x16_bf16 v[240:255], v[68:71], v[176:179], v[240:255]
    s_add_u32 s58, s58, 4096
    buffer_load_dwordx4 v[176:179], v12, s[28:31], s58 offen offset:0 sc1
    ds_read_b64_tr_b16 v[68:69], v11 offset:12288
    ds_read_b64_tr_b16 v[70:71], v11 offset:12800
    s_waitcnt vmcnt(15) lgkmcnt(6)
    v_mfma_f32_32x32x16_bf16 v[224:239], v[72:75], v[180:183], v[224:239]
    ds_read_b64_tr_b16 v[72:73], v10 offset:14336
    ds_read_b64_tr_b16 v[74:75], v10 offset:14848
    s_waitcnt lgkmcnt(6)
    v_mfma_f32_32x32x16_bf16 v[240:255], v[76:79], v[180:183], v[240:255]
    buffer_load_dwordx4 v[180:183], v12, s[28:31], s58 offen offset:1024 sc1
    ds_read_b64_tr_b16 v[76:77], v11 offset:14336
    ds_read_b64_tr_b16 v[78:79], v11 offset:14848
    s_waitcnt vmcnt(15) lgkmcnt(6)
    v_mfma_f32_32x32x16_bf16 v[224:239], v[64:67], v[184:187], v[224:239]
    ds_read_b64_tr_b16 v[64:65], v10 offset:16384
    ds_read_b64_tr_b16 v[66:67], v10 offset:16896
    s_waitcnt lgkmcnt(6)
    v_mfma_f32_32x32x16_bf16 v[240:255], v[68:71], v[184:187], v[240:255]
    buffer_load_dwordx4 v[184:187], v12, s[28:31], s58 offen offset:2048 sc1
    ds_read_b64_tr_b16 v[68:69], v11 offset:16384
    ds_read_b64_tr_b16 v[70:71], v11 offset:16896
    s_waitcnt vmcnt(15) lgkmcnt(6)
    v_mfma_f32_32x32x16_bf16 v[224:239], v[72:75], v[188:191], v[224:239]
    ds_read_b64_tr_b16 v[72:73], v10 offset:18432
    ds_read_b64_tr_b16 v[74:75], v10 offset:18944
    s_waitcnt lgkmcnt(6)
    v_mfma_f32_32x32x16_bf16 v[240:255], v[76:79], v[188:191], v[240:255]
    buffer_load_dwordx4 v[188:191], v12, s[28:31], s58 offen offset:3072 sc1
    ds_read_b64_tr_b16 v[76:77], v11 offset:18432
    ds_read_b64_tr_b16 v[78:79], v11 offset:18944
    s_barrier
    s_waitcnt vmcnt(15) lgkmcnt(6)
    v_mfma_f32_32x32x16_bf16 v[224:239], v[64:67], v[192:195], v[224:239]
    ds_read_b64_tr_b16 v[64:65], v10 offset:20480
    ds_read_b64_tr_b16 v[66:67], v10 offset:20992
    s_waitcnt lgkmcnt(6)
    v_mfma_f32_32x32x16_bf16 v[240:255], v[68:71], v[192:195], v[240:255]
    s_add_u32 s58, s58, 4096
    buffer_load_dwordx4 v[192:195], v12, s[28:31], s58 offen offset:0 sc1
    ds_read_b64_tr_b16 v[68:69], v11 offset:20480
    ds_read_b64_tr_b16 v[70:71], v11 offset:20992
    s_waitcnt vmcnt(15) lgkmcnt(6)
    v_mfma_f32_32x32x16_bf16 v[224:239], v[72:75], v[196:199], v[224:239]
    ds_read_b64_tr_b16 v[72:73], v10 offset:22528
    ds_read_b64_tr_b16 v[74:75], v10 offset:23040
    s_waitcnt lgkmcnt(6)
    v_mfma_f32_32x32x16_bf16 v[240:255], v[76:79], v[196:199], v[240:255]
    buffer_load_dwordx4 v[196:199], v12, s[28:31], s58 offen offset:1024 sc1
    ds_read_b64_tr_b16 v[76:77], v11 offset:22528
    ds_read_b64_tr_b16 v[78:79], v11 offset:23040
    s_waitcnt vmcnt(15) lgkmcnt(6)
    v_mfma_f32_32x32x16_bf16 v[224:239], v[64:67], v[200:203], v[224:239]
    ds_read_b64_tr_b16 v[64:65], v10 offset:24576
    ds_read_b64_tr_b16 v[66:67], v10 offset:25088
    s_waitcnt lgkmcnt(6)
    v_mfma_f32_32x32x16_bf16 v[240:255], v[68:71], v[200:203], v[240:255]
    buffer_load_dwordx4 v[200:203], v12, s[28:31], s58 offen offset:2048 sc1
    ds_read_b64_tr_b16 v[68:69], v11 offset:24576
    ds_read_b64_tr_b16 v[70:71], v11 offset:25088
    s_waitcnt vmcnt(15) lgkmcnt(6)
    v_mfma_f32_32x32x16_bf16 v[224:239], v[72:75], v[204:207], v[224:239]
    ds_read_b64_tr_b16 v[72:73], v10 offset:26624
    ds_read_b64_tr_b16 v[74:75], v10 offset:27136
    s_waitcnt lgkmcnt(6)
    v_mfma_f32_32x32x16_bf16 v[240:255], v[76:79], v[204:207], v[240:255]
    buffer_load_dwordx4 v[204:207], v12, s[28:31], s58 offen offset:3072 sc1
    ds_read_b64_tr_b16 v[76:77], v11 offset:26624
    ds_read_b64_tr_b16 v[78:79], v11 offset:27136
    s_waitcnt vmcnt(15) lgkmcnt(6)
    v_mfma_f32_32x32x16_bf16 v[224:239], v[64:67], v[208:211], v[224:239]
    ds_read_b64_tr_b16 v[64:65], v10 offset:28672
    ds_read_b64_tr_b16 v[66:67], v10 offset:29184
    s_waitcnt lgkmcnt(6)
    v_mfma_f32_32x32x16_bf16 v[240:255], v[68:71], v[208:211], v[240:255]
    s_add_u32 s58, s58, 4096
    buffer_load_dwordx4 v[208:211], v12, s[28:31], s58 offen offset:0 sc1
    ds_read_b64_tr_b16 v[68:69], v11 offset:28672
    ds_read_b64_tr_b16 v[70:71], v11 offset:29184
    s_waitcnt vmcnt(15) lgkmcnt(6)
    v_mfma_f32_32x32x16_bf16 v[224:239], v[72:75], v[212:215], v[224:239]
    ds_read_b64_tr_b16 v[72:73], v10 offset:30720
    ds_read_b64_tr_b16 v[74:75], v10 offset:31232
    s_waitcnt lgkmcnt(6)
    v_mfma_f32_32x32x16_bf16 v[240:255], v[76:79], v[212:215], v[240:255]
    buffer_load_dwordx4 v[212:215], v12, s[28:31], s58 offen offset:1024 sc1
    ds_read_b64_tr_b16 v[76:77], v11 offset:30720
    ds_read_b64_tr_b16 v[78:79], v11 offset:31232
    s_waitcnt vmcnt(15) lgkmcnt(6)
    v_mfma_f32_32x32x16_bf16 v[224:239], v[64:67], v[216:219], v[224:239]
    v_add_u32 v10, 0xfffe0000, v10
    v_add_u32 v11, 0xfffe0000, v11
    ds_read_b64_tr_b16 v[64:65], v10 offset:0
    ds_read_b64_tr_b16 v[66:67], v10 offset:512
    s_waitcnt lgkmcnt(6)
    v_mfma_f32_32x32x16_bf16 v[240:255], v[68:71], v[216:219], v[240:255]
    buffer_load_dwordx4 v[216:219], v12, s[28:31], s58 offen offset:2048 sc1
    ds_read_b64_tr_b16 v[68:69], v11 offset:0
    ds_read_b64_tr_b16 v[70:71], v11 offset:512
    s_waitcnt vmcnt(15) lgkmcnt(6)
    v_mfma_f32_32x32x16_bf16 v[224:239], v[72:75], v[220:223], v[224:239]
    ds_read_b64_tr_b16 v[72:73], v10 offset:2048
    ds_read_b64_tr_b16 v[74:75], v10 offset:2560
    s_waitcnt lgkmcnt(6)
    v_mfma_f32_32x32x16_bf16 v[240:255], v[76:79], v[220:223], v[240:255]
    buffer_load_dwordx4 v[220:223], v12, s[28:31], s58 offen offset:3072 sc1
    ds_read_b64_tr_b16 v[76:77], v11 offset:2048
    ds_read_b64_tr_b16 v[78:79], v11 offset:2560
    s_waitcnt vmcnt(15) lgkmcnt(6)
    v_mfma_f32_32x32x16_bf16 v[224:239], v[64:67], v[160:163], v[224:239]
    ds_read_b64_tr_b16 v[64:65], v10 offset:4096
    ds_read_b64_tr_b16 v[66:67], v10 offset:4608
    s_waitcnt lgkmcnt(6)
    v_mfma_f32_32x32x16_bf16 v[240:255], v[68:71], v[160:163], v[240:255]
    ds_read_b64_tr_b16 v[68:69], v11 offset:4096
    ds_read_b64_tr_b16 v[70:71], v11 offset:4608
    s_waitcnt vmcnt(14) lgkmcnt(6)
    v_mfma_f32_32x32x16_bf16 v[224:239], v[72:75], v[164:167], v[224:239]
    ds_read_b64_tr_b16 v[72:73], v10 offset:6144
    ds_read_b64_tr_b16 v[74:75], v10 offset:6656
    s_waitcnt lgkmcnt(6)
    v_mfma_f32_32x32x16_bf16 v[240:255], v[76:79], v[164:167], v[240:255]
    ds_read_b64_tr_b16 v[76:77], v11 offset:6144
    ds_read_b64_tr_b16 v[78:79], v11 offset:6656
    s_waitcnt vmcnt(13) lgkmcnt(6)
    v_mfma_f32_32x32x16_bf16 v[224:239], v[64:67], v[168:171], v[224:239]
    ds_read_b64_tr_b16 v[64:65], v10 offset:8192
    ds_read_b64_tr_b16 v[66:67], v10 offset:8704
    s_waitcnt lgkmcnt(6)
    v_mfma_f32_32x32x16_bf16 v[240:255], v[68:71], v[168:171], v[240:255]
    ds_read_b64_tr_b16 v[68:69], v11 offset:8192
    ds_read_b64_tr_b16 v[70:71], v11 offset:8704
    s_waitcnt vmcnt(12) lgkmcnt(6)
    v_mfma_f32_32x32x16_bf16 v[224:239], v[72:75], v[172:175], v[224:239]
    ds_read_b64_tr_b16 v[72:73], v10 offset:10240
    ds_read_b64_tr_b16 v[74:75], v10 offset:10752
    s_waitcnt lgkmcnt(6)
    v_mfma_f32_32x32x16_bf16 v[240:255], v[76:79], v[172:175], v[240:255]
    ds_read_b64_tr_b16 v[76:77], v11 offset:10240
    ds_read_b64_tr_b16 v[78:79], v11 offset:10752
    s_waitcnt vmcnt(11) lgkmcnt(6)
    v_mfma_f32_32x32x16_bf16 v[224:239], v[64:67], v[176:179], v[224:239]
    ds_read_b64_tr_b16 v[64:65], v10 offset:12288
    ds_read_b64_tr_b16 v[66:67], v10 offset:12800
    s_waitcnt lgkmcnt(6)
    v_mfma_f32_32x32x16_bf16 v[240:255], v[68:71], v[176:179], v[240:255]
    ds_read_b64_tr_b16 v[68:69], v11 offset:12288
    ds_read_b64_tr_b16 v[70:71], v11 offset:12800
    s_waitcnt vmcnt(10) lgkmcnt(6)
    v_mfma_f32_32x32x16_bf16 v[224:239], v[72:75], v[180:183], v[224:239]
    ds_read_b64_tr_b16 v[72:73], v10 offset:14336
    ds_read_b64_tr_b16 v[74:75], v10 offset:14848
    s_waitcnt lgkmcnt(6)
    v_mfma_f32_32x32x16_bf16 v[240:255], v[76:79], v[180:183], v[240:255]
    ds_read_b64_tr_b16 v[76:77], v11 offset:14336
    ds_read_b64_tr_b16 v[78:79], v11 offset:14848
    s_waitcnt vmcnt(9) lgkmcnt(6)
    v_mfma_f32_32x32x16_bf16 v[224:239], v[64:67], v[184:187], v[224:239]
    ds_read_b64_tr_b16 v[64:65], v10 offset:16384
    ds_read_b64_tr_b16 v[66:67], v10 offset:16896
    s_waitcnt lgkmcnt(6)
    v_mfma_f32_32x32x16_bf16 v[240:255], v[68:71], v[184:187], v[240:255]
    ds_read_b64_tr_b16 v[68:69], v11 offset:16384
    ds_read_b64_tr_b16 v[70:71], v11 offset:16896
    s_waitcnt vmcnt(8) lgkmcnt(6)
    v_mfma_f32_32x32x16_bf16 v[224:239], v[72:75], v[188:191], v[224:239]
    ds_read_b64_tr_b16 v[72:73], v10 offset:18432
    ds_read_b64_tr_b16 v[74:75], v10 offset:18944
    s_waitcnt lgkmcnt(6)
    v_mfma_f32_32x32x16_bf16 v[240:255], v[76:79], v[188:191], v[240:255]
    ds_read_b64_tr_b16 v[76:77], v11 offset:18432
    ds_read_b64_tr_b16 v[78:79], v11 offset:18944
    s_waitcnt vmcnt(7) lgkmcnt(6)
    v_mfma_f32_32x32x16_bf16 v[224:239], v[64:67], v[192:195], v[224:239]
    ds_read_b64_tr_b16 v[64:65], v10 offset:20480
    ds_read_b64_tr_b16 v[66:67], v10 offset:20992
    s_waitcnt lgkmcnt(6)
    v_mfma_f32_32x32x16_bf16 v[240:255], v[68:71], v[192:195], v[240:255]
    ds_read_b64_tr_b16 v[68:69], v11 offset:20480
    ds_read_b64_tr_b16 v[70:71], v11 offset:20992
    s_waitcnt vmcnt(6) lgkmcnt(6)
    v_mfma_f32_32x32x16_bf16 v[224:239], v[72:75], v[196:199], v[224:239]
    ds_read_b64_tr_b16 v[72:73], v10 offset:22528
    ds_read_b64_tr_b16 v[74:75], v10 offset:23040
    s_waitcnt lgkmcnt(6)
    v_mfma_f32_32x32x16_bf16 v[240:255], v[76:79], v[196:199], v[240:255]
    ds_read_b64_tr_b16 v[76:77], v11 offset:22528
    ds_read_b64_tr_b16 v[78:79], v11 offset:23040
    s_waitcnt vmcnt(5) lgkmcnt(6)
    v_mfma_f32_32x32x16_bf16 v[224:239], v[64:67], v[200:203], v[224:239]
    ds_read_b64_tr_b16 v[64:65], v10 offset:24576
    ds_read_b64_tr_b16 v[66:67], v10 offset:25088
    s_waitcnt lgkmcnt(6)
    v_mfma_f32_32x32x16_bf16 v[240:255], v[68:71], v[200:203], v[240:255]
    ds_read_b64_tr_b16 v[68:69], v11 offset:24576
    ds_read_b64_tr_b16 v[70:71], v11 offset:25088
    s_waitcnt vmcnt(4) lgkmcnt(6)
    v_mfma_f32_32x32x16_bf16 v[224:239], v[72:75], v[204:207], v[224:239]
    ds_read_b64_tr_b16 v[72:73], v10 offset:26624
    ds_read_b64_tr_b16 v[74:75], v10 offset:27136
    s_waitcnt lgkmcnt(6)
    v_mfma_f32_32x32x16_bf16 v[240:255], v[76:79], v[204:207], v[240:255]
    ds_read_b64_tr_b16 v[76:77], v11 offset:26624
    ds_read_b64_tr_b16 v[78:79], v11 offset:27136
    s_waitcnt vmcnt(3) lgkmcnt(6)
    v_mfma_f32_32x32x16_bf16 v[224:239], v[64:67], v[208:211], v[224:239]
    ds_read_b64_tr_b16 v[64:65], v10 offset:28672
    ds_read_b64_tr_b16 v[66:67], v10 offset:29184
    s_waitcnt lgkmcnt(6)
    v_mfma_f32_32x32x16_bf16 v[240:255], v[68:71], v[208:211], v[240:255]
    ds_read_b64_tr_b16 v[68:69], v11 offset:28672
    ds_read_b64_tr_b16 v[70:71], v11 offset:29184
    s_waitcnt vmcnt(2) lgkmcnt(6)
    v_mfma_f32_32x32x16_bf16 v[224:239], v[72:75], v[212:215], v[224:239]
    ds_read_b64_tr_b16 v[72:73], v10 offset:30720
    ds_read_b64_tr_b16 v[74:75], v10 offset:31232
    s_waitcnt lgkmcnt(6)
    v_mfma_f32_32x32x16_bf16 v[240:255], v[76:79], v[212:215], v[240:255]
    ds_read_b64_tr_b16 v[76:77], v11 offset:30720
    ds_read_b64_tr_b16 v[78:79], v11 offset:31232
    s_waitcnt vmcnt(1) lgkmcnt(6)
    v_mfma_f32_32x32x16_bf16 v[224:239], v[64:67], v[216:219], v[224:239]
    ds_read_b64_tr_b16 v[64:65], v10 offset:32768
    ds_read_b64_tr_b16 v[66:67], v10 offset:33280
    s_waitcnt lgkmcnt(6)
    v_mfma_f32_32x32x16_bf16 v[240:255], v[68:71], v[216:219], v[240:255]
    ds_read_b64_tr_b16 v[68:69], v11 offset:32768
    ds_read_b64_tr_b16 v[70:71], v11 offset:33280
    s_waitcnt vmcnt(0) lgkmcnt(6)
    v_mfma_f32_32x32x16_bf16 v[224:239], v[72:75], v[220:223], v[224:239]
    ds_read_b64_tr_b16 v[72:73], v10 offset:34816
    ds_read_b64_tr_b16 v[74:75], v10 offset:35328
    s_waitcnt lgkmcnt(6)
    v_mfma_f32_32x32x16_bf16 v[240:255], v[76:79], v[220:223], v[240:255]
    ds_read_b64_tr_b16 v[76:77], v11 offset:34816
    ds_read_b64_tr_b16 v[78:79], v11 offset:35328
    s_barrier
    s_add_u32 s58, s58, 4096
    buffer_load_dwordx4 v[160:163], v12, s[28:31], s58 offen offset:0 sc1
    buffer_load_dwordx4 v[164:167], v12, s[28:31], s58 offen offset:1024 sc1
    buffer_load_dwordx4 v[168:171], v12, s[28:31], s58 offen offset:2048 sc1
    buffer_load_dwordx4 v[172:175], v12, s[28:31], s58 offen offset:3072 sc1
    s_add_u32 s58, s58, 4096
    buffer_load_dwordx4 v[176:179], v12, s[28:31], s58 offen offset:0 sc1
    buffer_load_dwordx4 v[180:183], v12, s[28:31], s58 offen offset:1024 sc1
    buffer_load_dwordx4 v[184:187], v12, s[28:31], s58 offen offset:2048 sc1
    buffer_load_dwordx4 v[188:191], v12, s[28:31], s58 offen offset:3072 sc1
    s_add_u32 s58, s58, 4096
    buffer_load_dwordx4 v[192:195], v12, s[28:31], s58 offen offset:0 sc1
    buffer_load_dwordx4 v[196:199], v12, s[28:31], s58 offen offset:1024 sc1
    buffer_load_dwordx4 v[200:203], v12, s[28:31], s58 offen offset:2048 sc1
    buffer_load_dwordx4 v[204:207], v12, s[28:31], s58 offen offset:3072 sc1
    s_add_u32 s58, s58, 4096
    buffer_load_dwordx4 v[208:211], v12, s[28:31], s58 offen offset:0 sc1
    buffer_load_dwordx4 v[212:215], v12, s[28:31], s58 offen offset:1024 sc1
    buffer_load_dwordx4 v[216:219], v12, s[28:31], s58 offen offset:2048 sc1
    buffer_load_dwordx4 v[220:223], v12, s[28:31], s58 offen offset:3072 sc1
    s_waitcnt vmcnt(15) lgkmcnt(6)
    v_mfma_f32_32x32x16_bf16 v[224:239], v[64:67], v[160:163], v[224:239]
    ds_read_b64_tr_b16 v[64:65], v10 offset:36864
    ds_read_b64_tr_b16 v[66:67], v10 offset:37376
    s_waitcnt lgkmcnt(6)
    v_mfma_f32_32x32x16_bf16 v[240:255], v[68:71], v[160:163], v[240:255]
    s_add_u32 s58, s58, 4096
    buffer_load_dwordx4 v[160:163], v12, s[28:31], s58 offen offset:0 sc1
    ds_read_b64_tr_b16 v[68:69], v11 offset:36864
    ds_read_b64_tr_b16 v[70:71], v11 offset:37376
    s_waitcnt vmcnt(15) lgkmcnt(6)
    v_mfma_f32_32x32x16_bf16 v[224:239], v[72:75], v[164:167], v[224:239]
    ds_read_b64_tr_b16 v[72:73], v10 offset:38912
    ds_read_b64_tr_b16 v[74:75], v10 offset:39424
    s_waitcnt lgkmcnt(6)
    v_mfma_f32_32x32x16_bf16 v[240:255], v[76:79], v[164:167], v[240:255]
    buffer_load_dwordx4 v[164:167], v12, s[28:31], s58 offen offset:1024 sc1
    ds_read_b64_tr_b16 v[76:77], v11 offset:38912
    ds_read_b64_tr_b16 v[78:79], v11 offset:39424
    s_waitcnt vmcnt(15) lgkmcnt(6)
    v_mfma_f32_32x32x16_bf16 v[224:239], v[64:67], v[168:171], v[224:239]
    ds_read_b64_tr_b16 v[64:65], v10 offset:40960
    ds_read_b64_tr_b16 v[66:67], v10 offset:41472
    s_waitcnt lgkmcnt(6)
    v_mfma_f32_32x32x16_bf16 v[240:255], v[68:71], v[168:171], v[240:255]
    buffer_load_dwordx4 v[168:171], v12, s[28:31], s58 offen offset:2048 sc1
    ds_read_b64_tr_b16 v[68:69], v11 offset:40960
    ds_read_b64_tr_b16 v[70:71], v11 offset:41472
    s_waitcnt vmcnt(15) lgkmcnt(6)
    v_mfma_f32_32x32x16_bf16 v[224:239], v[72:75], v[172:175], v[224:239]
    ds_read_b64_tr_b16 v[72:73], v10 offset:43008
    ds_read_b64_tr_b16 v[74:75], v10 offset:43520
    s_waitcnt lgkmcnt(6)
    v_mfma_f32_32x32x16_bf16 v[240:255], v[76:79], v[172:175], v[240:255]
    buffer_load_dwordx4 v[172:175], v12, s[28:31], s58 offen offset:3072 sc1
    ds_read_b64_tr_b16 v[76:77], v11 offset:43008
    ds_read_b64_tr_b16 v[78:79], v11 offset:43520
    s_waitcnt vmcnt(15) lgkmcnt(6)
    v_mfma_f32_32x32x16_bf16 v[224:239], v[64:67], v[176:179], v[224:239]
    ds_read_b64_tr_b16 v[64:65], v10 offset:45056
    ds_read_b64_tr_b16 v[66:67], v10 offset:45568
    s_waitcnt lgkmcnt(6)
    v_mfma_f32_32x32x16_bf16 v[240:255], v[68:71], v[176:179], v[240:255]
    s_add_u32 s58, s58, 4096
    buffer_load_dwordx4 v[176:179], v12, s[28:31], s58 offen offset:0 sc1
    ds_read_b64_tr_b16 v[68:69], v11 offset:45056
    ds_read_b64_tr_b16 v[70:71], v11 offset:45568
    s_waitcnt vmcnt(15) lgkmcnt(6)
    v_mfma_f32_32x32x16_bf16 v[224:239], v[72:75], v[180:183], v[224:239]
    ds_read_b64_tr_b16 v[72:73], v10 offset:47104
    ds_read_b64_tr_b16 v[74:75], v10 offset:47616
    s_waitcnt lgkmcnt(6)
    v_mfma_f32_32x32x16_bf16 v[240:255], v[76:79], v[180:183], v[240:255]
    buffer_load_dwordx4 v[180:183], v12, s[28:31], s58 offen offset:1024 sc1
    ds_read_b64_tr_b16 v[76:77], v11 offset:47104
    ds_read_b64_tr_b16 v[78:79], v11 offset:47616
    s_waitcnt vmcnt(15) lgkmcnt(6)
    v_mfma_f32_32x32x16_bf16 v[224:239], v[64:67], v[184:187], v[224:239]
    ds_read_b64_tr_b16 v[64:65], v10 offset:49152
    ds_read_b64_tr_b16 v[66:67], v10 offset:49664
    s_waitcnt lgkmcnt(6)
    v_mfma_f32_32x32x16_bf16 v[240:255], v[68:71], v[184:187], v[240:255]
    buffer_load_dwordx4 v[184:187], v12, s[28:31], s58 offen offset:2048 sc1
    ds_read_b64_tr_b16 v[68:69], v11 offset:49152
    ds_read_b64_tr_b16 v[70:71], v11 offset:49664
    s_waitcnt vmcnt(15) lgkmcnt(6)
    v_mfma_f32_32x32x16_bf16 v[224:239], v[72:75], v[188:191], v[224:239]
    ds_read_b64_tr_b16 v[72:73], v10 offset:51200
    ds_read_b64_tr_b16 v[74:75], v10 offset:51712
    s_waitcnt lgkmcnt(6)
    v_mfma_f32_32x32x16_bf16 v[240:255], v[76:79], v[188:191], v[240:255]
    buffer_load_dwordx4 v[188:191], v12, s[28:31], s58 offen offset:3072 sc1
    ds_read_b64_tr_b16 v[76:77], v11 offset:51200
    ds_read_b64_tr_b16 v[78:79], v11 offset:51712
    s_waitcnt vmcnt(15) lgkmcnt(6)
    v_mfma_f32_32x32x16_bf16 v[224:239], v[64:67], v[192:195], v[224:239]
    ds_read_b64_tr_b16 v[64:65], v10 offset:53248
    ds_read_b64_tr_b16 v[66:67], v10 offset:53760
    s_waitcnt lgkmcnt(6)
    v_mfma_f32_32x32x16_bf16 v[240:255], v[68:71], v[192:195], v[240:255]
    s_add_u32 s58, s58, 4096
    buffer_load_dwordx4 v[192:195], v12, s[28:31], s58 offen offset:0 sc1
    ds_read_b64_tr_b16 v[68:69], v11 offset:53248
    ds_read_b64_tr_b16 v[70:71], v11 offset:53760
    s_waitcnt vmcnt(15) lgkmcnt(6)
    v_mfma_f32_32x32x16_bf16 v[224:239], v[72:75], v[196:199], v[224:239]
    ds_read_b64_tr_b16 v[72:73], v10 offset:55296
    ds_read_b64_tr_b16 v[74:75], v10 offset:55808
    s_waitcnt lgkmcnt(6)
    v_mfma_f32_32x32x16_bf16 v[240:255], v[76:79], v[196:199], v[240:255]
    buffer_load_dwordx4 v[196:199], v12, s[28:31], s58 offen offset:1024 sc1
    ds_read_b64_tr_b16 v[76:77], v11 offset:55296
    ds_read_b64_tr_b16 v[78:79], v11 offset:55808
    s_waitcnt vmcnt(15) lgkmcnt(6)
    v_mfma_f32_32x32x16_bf16 v[224:239], v[64:67], v[200:203], v[224:239]
    ds_read_b64_tr_b16 v[64:65], v10 offset:57344
    ds_read_b64_tr_b16 v[66:67], v10 offset:57856
    s_waitcnt lgkmcnt(6)
    v_mfma_f32_32x32x16_bf16 v[240:255], v[68:71], v[200:203], v[240:255]
    buffer_load_dwordx4 v[200:203], v12, s[28:31], s58 offen offset:2048 sc1
    ds_read_b64_tr_b16 v[68:69], v11 offset:57344
    ds_read_b64_tr_b16 v[70:71], v11 offset:57856
    s_waitcnt vmcnt(15) lgkmcnt(6)
    v_mfma_f32_32x32x16_bf16 v[224:239], v[72:75], v[204:207], v[224:239]
    ds_read_b64_tr_b16 v[72:73], v10 offset:59392
    ds_read_b64_tr_b16 v[74:75], v10 offset:59904
    s_waitcnt lgkmcnt(6)
    v_mfma_f32_32x32x16_bf16 v[240:255], v[76:79], v[204:207], v[240:255]
    buffer_load_dwordx4 v[204:207], v12, s[28:31], s58 offen offset:3072 sc1
    ds_read_b64_tr_b16 v[76:77], v11 offset:59392
    ds_read_b64_tr_b16 v[78:79], v11 offset:59904
    s_waitcnt vmcnt(15) lgkmcnt(6)
    v_mfma_f32_32x32x16_bf16 v[224:239], v[64:67], v[208:211], v[224:239]
    ds_read_b64_tr_b16 v[64:65], v10 offset:61440
    ds_read_b64_tr_b16 v[66:67], v10 offset:61952
    s_waitcnt lgkmcnt(6)
    v_mfma_f32_32x32x16_bf16 v[240:255], v[68:71], v[208:211], v[240:255]
    s_add_u32 s58, s58, 4096
    buffer_load_dwordx4 v[208:211], v12, s[28:31], s58 offen offset:0 sc1
    ds_read_b64_tr_b16 v[68:69], v11 offset:61440
    ds_read_b64_tr_b16 v[70:71], v11 offset:61952
    s_waitcnt vmcnt(15) lgkmcnt(6)
    v_mfma_f32_32x32x16_bf16 v[224:239], v[72:75], v[212:215], v[224:239]
    ds_read_b64_tr_b16 v[72:73], v10 offset:63488
    ds_read_b64_tr_b16 v[74:75], v10 offset:64000
    s_waitcnt lgkmcnt(6)
    v_mfma_f32_32x32x16_bf16 v[240:255], v[76:79], v[212:215], v[240:255]
    buffer_load_dwordx4 v[212:215], v12, s[28:31], s58 offen offset:1024 sc1
    ds_read_b64_tr_b16 v[76:77], v11 offset:63488
    ds_read_b64_tr_b16 v[78:79], v11 offset:64000
    s_waitcnt vmcnt(15) lgkmcnt(6)
    v_mfma_f32_32x32x16_bf16 v[224:239], v[64:67], v[216:219], v[224:239]
    v_add_u32 v10, 0x10000, v10
    v_add_u32 v11, 0x10000, v11
    ds_read_b64_tr_b16 v[64:65], v10 offset:0
    ds_read_b64_tr_b16 v[66:67], v10 offset:512
    s_waitcnt lgkmcnt(6)
    v_mfma_f32_32x32x16_bf16 v[240:255], v[68:71], v[216:219], v[240:255]
    buffer_load_dwordx4 v[216:219], v12, s[28:31], s58 offen offset:2048 sc1
    ds_read_b64_tr_b16 v[68:69], v11 offset:0
    ds_read_b64_tr_b16 v[70:71], v11 offset:512
    s_waitcnt vmcnt(15) lgkmcnt(6)
    v_mfma_f32_32x32x16_bf16 v[224:239], v[72:75], v[220:223], v[224:239]
    ds_read_b64_tr_b16 v[72:73], v10 offset:2048
    ds_read_b64_tr_b16 v[74:75], v10 offset:2560
    s_waitcnt lgkmcnt(6)
    v_mfma_f32_32x32x16_bf16 v[240:255], v[76:79], v[220:223], v[240:255]
    buffer_load_dwordx4 v[220:223], v12, s[28:31], s58 offen offset:3072 sc1
    ds_read_b64_tr_b16 v[76:77], v11 offset:2048
    ds_read_b64_tr_b16 v[78:79], v11 offset:2560
    s_waitcnt vmcnt(15) lgkmcnt(6)
    v_mfma_f32_32x32x16_bf16 v[224:239], v[64:67], v[160:163], v[224:239]
    ds_read_b64_tr_b16 v[64:65], v10 offset:4096
    ds_read_b64_tr_b16 v[66:67], v10 offset:4608
    s_waitcnt lgkmcnt(6)
    v_mfma_f32_32x32x16_bf16 v[240:255], v[68:71], v[160:163], v[240:255]
    s_add_u32 s58, s58, 4096
    buffer_load_dwordx4 v[160:163], v12, s[28:31], s58 offen offset:0 sc1
    ds_read_b64_tr_b16 v[68:69], v11 offset:4096
    ds_read_b64_tr_b16 v[70:71], v11 offset:4608
    s_waitcnt vmcnt(15) lgkmcnt(6)
    v_mfma_f32_32x32x16_bf16 v[224:239], v[72:75], v[164:167], v[224:239]
    ds_read_b64_tr_b16 v[72:73], v10 offset:6144
    ds_read_b64_tr_b16 v[74:75], v10 offset:6656
    s_waitcnt lgkmcnt(6)
    v_mfma_f32_32x32x16_bf16 v[240:255], v[76:79], v[164:167], v[240:255]
    buffer_load_dwordx4 v[164:167], v12, s[28:31], s58 offen offset:1024 sc1
    ds_read_b64_tr_b16 v[76:77], v11 offset:6144
    ds_read_b64_tr_b16 v[78:79], v11 offset:6656
    s_waitcnt vmcnt(15) lgkmcnt(6)
    v_mfma_f32_32x32x16_bf16 v[224:239], v[64:67], v[168:171], v[224:239]
    ds_read_b64_tr_b16 v[64:65], v10 offset:8192
    ds_read_b64_tr_b16 v[66:67], v10 offset:8704
    s_waitcnt lgkmcnt(6)
    v_mfma_f32_32x32x16_bf16 v[240:255], v[68:71], v[168:171], v[240:255]
    buffer_load_dwordx4 v[168:171], v12, s[28:31], s58 offen offset:2048 sc1
    ds_read_b64_tr_b16 v[68:69], v11 offset:8192
    ds_read_b64_tr_b16 v[70:71], v11 offset:8704
    s_waitcnt vmcnt(15) lgkmcnt(6)
    v_mfma_f32_32x32x16_bf16 v[224:239], v[72:75], v[172:175], v[224:239]
    ds_read_b64_tr_b16 v[72:73], v10 offset:10240
    ds_read_b64_tr_b16 v[74:75], v10 offset:10752
    s_waitcnt lgkmcnt(6)
    v_mfma_f32_32x32x16_bf16 v[240:255], v[76:79], v[172:175], v[240:255]
    buffer_load_dwordx4 v[172:175], v12, s[28:31], s58 offen offset:3072 sc1
    ds_read_b64_tr_b16 v[76:77], v11 offset:10240
    ds_read_b64_tr_b16 v[78:79], v11 offset:10752
    s_barrier
    s_waitcnt vmcnt(15) lgkmcnt(6)
    v_mfma_f32_32x32x16_bf16 v[224:239], v[64:67], v[176:179], v[224:239]
    ds_read_b64_tr_b16 v[64:65], v10 offset:12288
    ds_read_b64_tr_b16 v[66:67], v10 offset:12800
    s_waitcnt lgkmcnt(6)
    v_mfma_f32_32x32x16_bf16 v[240:255], v[68:71], v[176:179], v[240:255]
    s_add_u32 s58, s58, 4096
    buffer_load_dwordx4 v[176:179], v12, s[28:31], s58 offen offset:0 sc1
    ds_read_b64_tr_b16 v[68:69], v11 offset:12288
    ds_read_b64_tr_b16 v[70:71], v11 offset:12800
    s_waitcnt vmcnt(15) lgkmcnt(6)
    v_mfma_f32_32x32x16_bf16 v[224:239], v[72:75], v[180:183], v[224:239]
    ds_read_b64_tr_b16 v[72:73], v10 offset:14336
    ds_read_b64_tr_b16 v[74:75], v10 offset:14848
    s_waitcnt lgkmcnt(6)
    v_mfma_f32_32x32x16_bf16 v[240:255], v[76:79], v[180:183], v[240:255]
    buffer_load_dwordx4 v[180:183], v12, s[28:31], s58 offen offset:1024 sc1
    ds_read_b64_tr_b16 v[76:77], v11 offset:14336
    ds_read_b64_tr_b16 v[78:79], v11 offset:14848
    s_waitcnt vmcnt(15) lgkmcnt(6)
    v_mfma_f32_32x32x16_bf16 v[224:239], v[64:67], v[184:187], v[224:239]
    ds_read_b64_tr_b16 v[64:65], v10 offset:16384
    ds_read_b64_tr_b16 v[66:67], v10 offset:16896
    s_waitcnt lgkmcnt(6)
    v_mfma_f32_32x32x16_bf16 v[240:255], v[68:71], v[184:187], v[240:255]
    buffer_load_dwordx4 v[184:187], v12, s[28:31], s58 offen offset:2048 sc1
    ds_read_b64_tr_b16 v[68:69], v11 offset:16384
    ds_read_b64_tr_b16 v[70:71], v11 offset:16896
    s_waitcnt vmcnt(15) lgkmcnt(6)
    v_mfma_f32_32x32x16_bf16 v[224:239], v[72:75], v[188:191], v[224:239]
    ds_read_b64_tr_b16 v[72:73], v10 offset:18432
    ds_read_b64_tr_b16 v[74:75], v10 offset:18944
    s_waitcnt lgkmcnt(6)
    v_mfma_f32_32x32x16_bf16 v[240:255], v[76:79], v[188:191], v[240:255]
    buffer_load_dwordx4 v[188:191], v12, s[28:31], s58 offen offset:3072 sc1
    ds_read_b64_tr_b16 v[76:77], v11 offset:18432
    ds_read_b64_tr_b16 v[78:79], v11 offset:18944
    s_waitcnt vmcnt(15) lgkmcnt(6)
    v_mfma_f32_32x32x16_bf16 v[224:239], v[64:67], v[192:195], v[224:239]
    ds_read_b64_tr_b16 v[64:65], v10 offset:20480
    ds_read_b64_tr_b16 v[66:67], v10 offset:20992
    s_waitcnt lgkmcnt(6)
    v_mfma_f32_32x32x16_bf16 v[240:255], v[68:71], v[192:195], v[240:255]
    ds_read_b64_tr_b16 v[68:69], v11 offset:20480
    ds_read_b64_tr_b16 v[70:71], v11 offset:20992
    s_waitcnt vmcnt(14) lgkmcnt(6)
    v_mfma_f32_32x32x16_bf16 v[224:239], v[72:75], v[196:199], v[224:239]
    ds_read_b64_tr_b16 v[72:73], v10 offset:22528
    ds_read_b64_tr_b16 v[74:75], v10 offset:23040
    s_waitcnt lgkmcnt(6)
    v_mfma_f32_32x32x16_bf16 v[240:255], v[76:79], v[196:199], v[240:255]
    ds_read_b64_tr_b16 v[76:77], v11 offset:22528
    ds_read_b64_tr_b16 v[78:79], v11 offset:23040
    s_waitcnt vmcnt(13) lgkmcnt(6)
    v_mfma_f32_32x32x16_bf16 v[224:239], v[64:67], v[200:203], v[224:239]
    ds_read_b64_tr_b16 v[64:65], v10 offset:24576
    ds_read_b64_tr_b16 v[66:67], v10 offset:25088
    s_waitcnt lgkmcnt(6)
    v_mfma_f32_32x32x16_bf16 v[240:255], v[68:71], v[200:203], v[240:255]
    ds_read_b64_tr_b16 v[68:69], v11 offset:24576
    ds_read_b64_tr_b16 v[70:71], v11 offset:25088
    s_waitcnt vmcnt(12) lgkmcnt(6)
    v_mfma_f32_32x32x16_bf16 v[224:239], v[72:75], v[204:207], v[224:239]
    ds_read_b64_tr_b16 v[72:73], v10 offset:26624
    ds_read_b64_tr_b16 v[74:75], v10 offset:27136
    s_waitcnt lgkmcnt(6)
    v_mfma_f32_32x32x16_bf16 v[240:255], v[76:79], v[204:207], v[240:255]
    ds_read_b64_tr_b16 v[76:77], v11 offset:26624
    ds_read_b64_tr_b16 v[78:79], v11 offset:27136
    s_waitcnt vmcnt(11) lgkmcnt(6)
    v_mfma_f32_32x32x16_bf16 v[224:239], v[64:67], v[208:211], v[224:239]
    ds_read_b64_tr_b16 v[64:65], v10 offset:28672
    ds_read_b64_tr_b16 v[66:67], v10 offset:29184
    s_waitcnt lgkmcnt(6)
    v_mfma_f32_32x32x16_bf16 v[240:255], v[68:71], v[208:211], v[240:255]
    ds_read_b64_tr_b16 v[68:69], v11 offset:28672
    ds_read_b64_tr_b16 v[70:71], v11 offset:29184
    s_waitcnt vmcnt(10) lgkmcnt(6)
    v_mfma_f32_32x32x16_bf16 v[224:239], v[72:75], v[212:215], v[224:239]
    ds_read_b64_tr_b16 v[72:73], v10 offset:30720
    ds_read_b64_tr_b16 v[74:75], v10 offset:31232
    s_waitcnt lgkmcnt(6)
    v_mfma_f32_32x32x16_bf16 v[240:255], v[76:79], v[212:215], v[240:255]
    ds_read_b64_tr_b16 v[76:77], v11 offset:30720
    ds_read_b64_tr_b16 v[78:79], v11 offset:31232
    s_waitcnt vmcnt(9) lgkmcnt(6)
    v_mfma_f32_32x32x16_bf16 v[224:239], v[64:67], v[216:219], v[224:239]
    ds_read_b64_tr_b16 v[64:65], v10 offset:32768
    ds_read_b64_tr_b16 v[66:67], v10 offset:33280
    s_waitcnt lgkmcnt(6)
    v_mfma_f32_32x32x16_bf16 v[240:255], v[68:71], v[216:219], v[240:255]
    ds_read_b64_tr_b16 v[68:69], v11 offset:32768
    ds_read_b64_tr_b16 v[70:71], v11 offset:33280
    s_waitcnt vmcnt(8) lgkmcnt(6)
    v_mfma_f32_32x32x16_bf16 v[224:239], v[72:75], v[220:223], v[224:239]
    ds_read_b64_tr_b16 v[72:73], v10 offset:34816
    ds_read_b64_tr_b16 v[74:75], v10 offset:35328
    s_waitcnt lgkmcnt(6)
    v_mfma_f32_32x32x16_bf16 v[240:255], v[76:79], v[220:223], v[240:255]
    ds_read_b64_tr_b16 v[76:77], v11 offset:34816
    ds_read_b64_tr_b16 v[78:79], v11 offset:35328
    s_waitcnt vmcnt(7) lgkmcnt(6)
    v_mfma_f32_32x32x16_bf16 v[224:239], v[64:67], v[160:163], v[224:239]
    ds_read_b64_tr_b16 v[64:65], v10 offset:36864
    ds_read_b64_tr_b16 v[66:67], v10 offset:37376
    s_waitcnt lgkmcnt(6)
    v_mfma_f32_32x32x16_bf16 v[240:255], v[68:71], v[160:163], v[240:255]
    ds_read_b64_tr_b16 v[68:69], v11 offset:36864
    ds_read_b64_tr_b16 v[70:71], v11 offset:37376
    s_waitcnt vmcnt(6) lgkmcnt(6)
    v_mfma_f32_32x32x16_bf16 v[224:239], v[72:75], v[164:167], v[224:239]
    ds_read_b64_tr_b16 v[72:73], v10 offset:38912
    ds_read_b64_tr_b16 v[74:75], v10 offset:39424
    s_waitcnt lgkmcnt(6)
    v_mfma_f32_32x32x16_bf16 v[240:255], v[76:79], v[164:167], v[240:255]
    ds_read_b64_tr_b16 v[76:77], v11 offset:38912
    ds_read_b64_tr_b16 v[78:79], v11 offset:39424
    s_waitcnt vmcnt(5) lgkmcnt(6)
    v_mfma_f32_32x32x16_bf16 v[224:239], v[64:67], v[168:171], v[224:239]
    ds_read_b64_tr_b16 v[64:65], v10 offset:40960
    ds_read_b64_tr_b16 v[66:67], v10 offset:41472
    s_waitcnt lgkmcnt(6)
    v_mfma_f32_32x32x16_bf16 v[240:255], v[68:71], v[168:171], v[240:255]
    ds_read_b64_tr_b16 v[68:69], v11 offset:40960
    ds_read_b64_tr_b16 v[70:71], v11 offset:41472
    s_waitcnt vmcnt(4) lgkmcnt(6)
    v_mfma_f32_32x32x16_bf16 v[224:239], v[72:75], v[172:175], v[224:239]
    ds_read_b64_tr_b16 v[72:73], v10 offset:43008
    ds_read_b64_tr_b16 v[74:75], v10 offset:43520
    s_waitcnt lgkmcnt(6)
    v_mfma_f32_32x32x16_bf16 v[240:255], v[76:79], v[172:175], v[240:255]
    ds_read_b64_tr_b16 v[76:77], v11 offset:43008
    ds_read_b64_tr_b16 v[78:79], v11 offset:43520
    s_waitcnt vmcnt(3) lgkmcnt(6)
    v_mfma_f32_32x32x16_bf16 v[224:239], v[64:67], v[176:179], v[224:239]
    ds_read_b64_tr_b16 v[64:65], v10 offset:45056
    ds_read_b64_tr_b16 v[66:67], v10 offset:45568
    s_waitcnt lgkmcnt(6)
    v_mfma_f32_32x32x16_bf16 v[240:255], v[68:71], v[176:179], v[240:255]
    ds_read_b64_tr_b16 v[68:69], v11 offset:45056
    ds_read_b64_tr_b16 v[70:71], v11 offset:45568
    s_waitcnt vmcnt(2) lgkmcnt(6)
    v_mfma_f32_32x32x16_bf16 v[224:239], v[72:75], v[180:183], v[224:239]
    ds_read_b64_tr_b16 v[72:73], v10 offset:47104
    ds_read_b64_tr_b16 v[74:75], v10 offset:47616
    s_waitcnt lgkmcnt(6)
    v_mfma_f32_32x32x16_bf16 v[240:255], v[76:79], v[180:183], v[240:255]
    ds_read_b64_tr_b16 v[76:77], v11 offset:47104
    ds_read_b64_tr_b16 v[78:79], v11 offset:47616
    s_waitcnt vmcnt(1) lgkmcnt(6)
    v_mfma_f32_32x32x16_bf16 v[224:239], v[64:67], v[184:187], v[224:239]
    s_waitcnt lgkmcnt(4)
    v_mfma_f32_32x32x16_bf16 v[240:255], v[68:71], v[184:187], v[240:255]
    s_waitcnt vmcnt(0) lgkmcnt(2)
    v_mfma_f32_32x32x16_bf16 v[224:239], v[72:75], v[188:191], v[224:239]
    s_waitcnt lgkmcnt(0)
    v_mfma_f32_32x32x16_bf16 v[240:255], v[76:79], v[188:191], v[240:255]
    s_mov_b32 s44, s20
    s_mov_b32 s45, s21
    s_mov_b32 s46, 2621440
    s_mov_b32 s47, 0x00020000
    v_and_b32 v4, 31, v1
    v_mul_u32_u24 v4, 1280, v4
    v_lshrrev_b32 v5, 5, v1
    v_lshl_add_u32 v4, v5, 4, v4
    v_lshlrev_b32 v6, 16, v80
    v_and_b32 v7, 0xffff0000, v80
    v_add_f32 v224, v224, v6
    v_add_f32 v225, v225, v7
    v_lshlrev_b32 v6, 16, v81
    v_and_b32 v7, 0xffff0000, v81
    v_add_f32 v226, v226, v6
    v_add_f32 v227, v227, v7
    v_lshlrev_b32 v6, 16, v82
    v_and_b32 v7, 0xffff0000, v82
    v_add_f32 v228, v228, v6
    v_add_f32 v229, v229, v7
    v_lshlrev_b32 v6, 16, v83
    v_and_b32 v7, 0xffff0000, v83
    v_add_f32 v230, v230, v6
    v_add_f32 v231, v231, v7
    v_lshlrev_b32 v6, 16, v84
    v_and_b32 v7, 0xffff0000, v84
    v_add_f32 v232, v232, v6
    v_add_f32 v233, v233, v7
    v_lshlrev_b32 v6, 16, v85
    v_and_b32 v7, 0xffff0000, v85
    v_add_f32 v234, v234, v6
    v_add_f32 v235, v235, v7
    v_lshlrev_b32 v6, 16, v86
    v_and_b32 v7, 0xffff0000, v86
    v_add_f32 v236, v236, v6
    v_add_f32 v237, v237, v7
    v_lshlrev_b32 v6, 16, v87
    v_and_b32 v7, 0xffff0000, v87
    v_add_f32 v238, v238, v6
    v_add_f32 v239, v239, v7
    v_cvt_pk_bf16_f32 v100, v224, v225
    v_cvt_pk_bf16_f32 v101, v226, v227
    v_cvt_pk_bf16_f32 v102, v228, v229
    v_cvt_pk_bf16_f32 v103, v230, v231
    v_cvt_pk_bf16_f32 v104, v232, v233
    v_cvt_pk_bf16_f32 v105, v234, v235
    v_cvt_pk_bf16_f32 v106, v236, v237
    v_cvt_pk_bf16_f32 v107, v238, v239
    v_permlane32_swap_b32 v100, v102
    v_permlane32_swap_b32 v101, v103
    v_permlane32_swap_b32 v104, v106
    v_permlane32_swap_b32 v105, v107
    buffer_store_dwordx4 v[100:103], v4, s[44:47], s76 offen offset:0 sc1
    buffer_store_dwordx4 v[104:107], v4, s[44:47], s76 offen offset:32 sc1
    v_lshlrev_b32 v6, 16, v88
    v_and_b32 v7, 0xffff0000, v88
    v_add_f32 v240, v240, v6
    v_add_f32 v241, v241, v7
    v_lshlrev_b32 v6, 16, v89
    v_and_b32 v7, 0xffff0000, v89
    v_add_f32 v242, v242, v6
    v_add_f32 v243, v243, v7
    v_lshlrev_b32 v6, 16, v90
    v_and_b32 v7, 0xffff0000, v90
    v_add_f32 v244, v244, v6
    v_add_f32 v245, v245, v7
    v_lshlrev_b32 v6, 16, v91
    v_and_b32 v7, 0xffff0000, v91
    v_add_f32 v246, v246, v6
    v_add_f32 v247, v247, v7
    v_lshlrev_b32 v6, 16, v92
    v_and_b32 v7, 0xffff0000, v92
    v_add_f32 v248, v248, v6
    v_add_f32 v249, v249, v7
    v_lshlrev_b32 v6, 16, v93
    v_and_b32 v7, 0xffff0000, v93
    v_add_f32 v250, v250, v6
    v_add_f32 v251, v251, v7
    v_lshlrev_b32 v6, 16, v94
    v_and_b32 v7, 0xffff0000, v94
    v_add_f32 v252, v252, v6
    v_add_f32 v253, v253, v7
    v_lshlrev_b32 v6, 16, v95
    v_and_b32 v7, 0xffff0000, v95
    v_add_f32 v254, v254, v6
    v_add_f32 v255, v255, v7
    v_cvt_pk_bf16_f32 v108, v240, v241
    v_cvt_pk_bf16_f32 v109, v242, v243
    v_cvt_pk_bf16_f32 v110, v244, v245
    v_cvt_pk_bf16_f32 v111, v246, v247
    v_cvt_pk_bf16_f32 v112, v248, v249
    v_cvt_pk_bf16_f32 v113, v250, v251
    v_cvt_pk_bf16_f32 v114, v252, v253
    v_cvt_pk_bf16_f32 v115, v254, v255
    v_permlane32_swap_b32 v108, v110
    v_permlane32_swap_b32 v109, v111
    v_permlane32_swap_b32 v112, v114
    v_permlane32_swap_b32 v113, v115
    buffer_store_dwordx4 v[108:111], v4, s[44:47], s76 offen offset:64 sc1
    buffer_store_dwordx4 v[112:115], v4, s[44:47], s76 offen offset:96 sc1
    s_branch L_end
L_p2_helper:
    s_sub_u32 s84, s52, 4
    s_lshl_b32 s58, s89, 7
    s_cmp_eq_u32 s52, 4
    s_cbranch_scc0 L_p2_h1
    s_lshl_b32 s78, s57, 8
    s_add_u32 s78, s78, 9060352
    s_mov_b32 s80, 0
    v_mov_b32 v3, 0
    buffer_load_dword v4, v3, s[36:39], s78 offen sc1
    buffer_load_dword v5, v3, s[36:39], s78 offen sc1
    s_sleep 3
    buffer_load_dword v6, v3, s[36:39], s78 offen sc1
    buffer_load_dword v7, v3, s[36:39], s78 offen sc1
    s_sleep 3
    buffer_load_dword v8, v3, s[36:39], s78 offen sc1
    buffer_load_dword v9, v3, s[36:39], s78 offen sc1
L_poll_17:
    s_waitcnt vmcnt(4)
    v_min_u32 v2, v4, v5
    s_nop 0
    v_readfirstlane_b32 s81, v2
    s_nop 3
    s_cmp_ge_u32 s81, 20
    s_cbranch_scc1 L_polld_18
    buffer_load_dword v4, v3, s[36:39], s78 offen sc1
    buffer_load_dword v5, v3, s[36:39], s78 offen sc1
    s_waitcnt vmcnt(4)
    v_min_u32 v2, v6, v7
    s_nop 0
    v_readfirstlane_b32 s81, v2
    s_nop 3
    s_cmp_ge_u32 s81, 20
    s_cbranch_scc1 L_polld_18
    buffer_load_dword v6, v3, s[36:39], s78 offen sc1
    buffer_load_dword v7, v3, s[36:39], s78 offen sc1
    s_waitcnt vmcnt(4)
    v_min_u32 v2, v8, v9
    s_nop 0
    v_readfirstlane_b32 s81, v2
    s_nop 3
    s_cmp_ge_u32 s81, 20
    s_cbranch_scc1 L_polld_18
    buffer_load_dword v8, v3, s[36:39], s78 offen sc1
    buffer_load_dword v9, v3, s[36:39], s78 offen sc1
    s_add_u32 s80, s80, 1
    s_cmp_le_u32 s80, 100000
    s_cbranch_scc1 L_poll_17
L_polld_18:
    s_waitcnt vmcnt(0)
L_p2_h1:
    s_waitcnt vmcnt(0)
    s_barrier
    s_barrier
    s_mul_i32 s78, s84, 20480
    s_add_u32 s78, s78, s58
    s_lshl_b32 s79, s84, 11
    s_add_u32 m0, s79, 0
    s_add_u32 s81, s78, 1638400
    buffer_load_dwordx4 v100, s[44:47], s81 offen lds
    s_add_u32 m0, s79, 1024
    s_add_u32 s81, s78, 1638400
    buffer_load_dwordx4 v101, s[44:47], s81 offen lds
    s_add_u32 m0, s79, 8192
    s_add_u32 s81, s78, 1720320
    buffer_load_dwordx4 v100, s[44:47], s81 offen lds
    s_add_u32 m0, s79, 9216
    s_add_u32 s81, s78, 1720320
    buffer_load_dwordx4 v101, s[44:47], s81 offen lds
    s_add_u32 m0, s79, 16384
    s_add_u32 s81, s78, 1802240
    buffer_load_dwordx4 v100, s[44:47], s81 offen lds
    s_add_u32 m0, s79, 17408
    s_add_u32 s81, s78, 1802240
    buffer_load_dwordx4 v101, s[44:47], s81 offen lds
    s_add_u32 m0, s79, 24576
    s_add_u32 s81, s78, 1884160
    buffer_load_dwordx4 v100, s[44:47], s81 offen lds
    s_add_u32 m0, s79, 25600
    s_add_u32 s81, s78, 1884160
    buffer_load_dwordx4 v101, s[44:47], s81 offen lds
    s_add_u32 m0, s79, 32768
    s_add_u32 s81, s78, 0
    buffer_load_dwordx4 v102, s[48:51], s81 offen lds
    s_add_u32 m0, s79, 33792
    s_add_u32 s81, s78, 0
    buffer_load_dwordx4 v103, s[48:51], s81 offen lds
    s_add_u32 m0, s79, 40960
    s_add_u32 s81, s78, 81920
    buffer_load_dwordx4 v102, s[48:51], s81 offen lds
    s_add_u32 m0, s79, 41984
    s_add_u32 s81, s78, 81920
    buffer_load_dwordx4 v103, s[48:51], s81 offen lds
    s_barrier
    s_mul_i32 s78, s84, 20480
    s_add_u32 s78, s78, s58
    s_lshl_b32 s79, s84, 11
    s_add_u32 m0, s79, 49152
    s_add_u32 s81, s78, 163840
    buffer_load_dwordx4 v102, s[48:51], s81 offen lds
    s_add_u32 m0, s79, 50176
    s_add_u32 s81, s78, 163840
    buffer_load_dwordx4 v103, s[48:51], s81 offen lds
    s_add_u32 m0, s79, 57344
    s_add_u32 s81, s78, 245760
    buffer_load_dwordx4 v102, s[48:51], s81 offen lds
    s_add_u32 m0, s79, 58368
    s_add_u32 s81, s78, 245760
    buffer_load_dwordx4 v103, s[48:51], s81 offen lds
    s_add_u32 m0, s79, 65536
    s_add_u32 s81, s78, 327680
    buffer_load_dwordx4 v102, s[48:51], s81 offen lds
    s_add_u32 m0, s79, 66560
    s_add_u32 s81, s78, 327680
    buffer_load_dwordx4 v103, s[48:51], s81 offen lds
    s_add_u32 m0, s79, 73728
    s_add_u32 s81, s78, 409600
    buffer_load_dwordx4 v102, s[48:51], s81 offen lds
    s_add_u32 m0, s79, 74752
    s_add_u32 s81, s78, 409600
    buffer_load_dwordx4 v103, s[48:51], s81 offen lds
    s_add_u32 m0, s79, 81920
    s_add_u32 s81, s78, 491520
    buffer_load_dwordx4 v102, s[48:51], s81 offen lds
    s_add_u32 m0, s79, 82944
    s_add_u32 s81, s78, 491520
    buffer_load_dwordx4 v103, s[48:51], s81 offen lds
    s_add_u32 m0, s79, 90112
    s_add_u32 s81, s78, 573440
    buffer_load_dwordx4 v102, s[48:51], s81 offen lds
    s_add_u32 m0, s79, 91136
    s_add_u32 s81, s78, 573440
    buffer_load_dwordx4 v103, s[48:51], s81 offen lds
    s_waitcnt vmcnt(12)
    s_barrier
    s_mul_i32 s78, s84, 20480
    s_add_u32 s78, s78, s58
    s_lshl_b32 s79, s84, 11
    s_add_u32 m0, s79, 98304
    s_add_u32 s81, s78, 655360
    buffer_load_dwordx4 v102, s[48:51], s81 offen lds
    s_add_u32 m0, s79, 99328
    s_add_u32 s81, s78, 655360
    buffer_load_dwordx4 v103, s[48:51], s81 offen lds
    s_add_u32 m0, s79, 106496
    s_add_u32 s81, s78, 737280
    buffer_load_dwordx4 v102, s[48:51], s81 offen lds
    s_add_u32 m0, s79, 107520
    s_add_u32 s81, s78, 737280
    buffer_load_dwordx4 v103, s[48:51], s81 offen lds
    s_cmp_eq_u32 s52, 4
    s_cbranch_scc0 L_p2_h2
    s_lshl_b32 s78, s57, 8
    s_add_u32 s78, s78, 9062400
    s_mov_b32 s80, 0
    v_mov_b32 v3, 0
    buffer_load_dword v4, v3, s[36:39], s78 offen sc1
    buffer_load_dword v5, v3, s[36:39], s78 offen sc1
    s_sleep 3
    buffer_load_dword v6, v3, s[36:39], s78 offen sc1
    buffer_load_dword v7, v3, s[36:39], s78 offen sc1
    s_sleep 3
    buffer_load_dword v8, v3, s[36:39], s78 offen sc1
    buffer_load_dword v9, v3, s[36:39], s78 offen sc1
L_poll_19:
    s_waitcnt vmcnt(4)
    v_min_u32 v2, v4, v5
    s_nop 0
    v_readfirstlane_b32 s81, v2
    s_nop 3
    s_cmp_ge_u32 s81, 4
    s_cbranch_scc1 L_polld_20
    buffer_load_dword v4, v3, s[36:39], s78 offen sc1
    buffer_load_dword v5, v3, s[36:39], s78 offen sc1
    s_waitcnt vmcnt(4)
    v_min_u32 v2, v6, v7
    s_nop 0
    v_readfirstlane_b32 s81, v2
    s_nop 3
    s_cmp_ge_u32 s81, 4
    s_cbranch_scc1 L_polld_20
    buffer_load_dword v6, v3, s[36:39], s78 offen sc1
    buffer_load_dword v7, v3, s[36:39], s78 offen sc1
    s_waitcnt vmcnt(4)
    v_min_u32 v2, v8, v9
    s_nop 0
    v_readfirstlane_b32 s81, v2
    s_nop 3
    s_cmp_ge_u32 s81, 4
    s_cbranch_scc1 L_polld_20
    buffer_load_dword v8, v3, s[36:39], s78 offen sc1
    buffer_load_dword v9, v3, s[36:39], s78 offen sc1
    s_add_u32 s80, s80, 1
    s_cmp_le_u32 s80, 100000
    s_cbranch_scc1 L_poll_19
L_polld_20:
    s_waitcnt vmcnt(0)
L_p2_h2:
    s_waitcnt vmcnt(4)
    s_barrier
    s_waitcnt vmcnt(0)
    s_barrier
    s_branch L_end
    s_branch L_end
L_end:
    s_endpgm
.section .rodata,"a"
.p2align 6
.amdhsa_kernel parallel_sum__linear_kernel_hedgehog__swiglu_ffn__prompt_kernel
  .amdhsa_next_free_vgpr 256
  .amdhsa_next_free_sgpr 102
  .amdhsa_accum_offset 256
  .amdhsa_group_segment_fixed_size 0
  .amdhsa_kernarg_size 88
  .amdhsa_user_sgpr_count 2
  .amdhsa_user_sgpr_kernarg_segment_ptr 1
  .amdhsa_system_sgpr_workgroup_id_x 1
.end_amdhsa_kernel
```
